```python
import torch

def _softmax(x, axis=-1):
    return torch.softmax(x, dim=axis)
def _gelu(x):
    return torch.nn.functional.gelu(x, approximate="tanh")
def _silu(x):
    return torch.nn.functional.silu(x)
def _sigmoid(x):
    return torch.sigmoid(x)
def _layernorm(x, axis=-1, eps=1e-5):
    m = x.mean(dim=axis, keepdim=True)
    v = x.var(dim=axis, keepdim=True, unbiased=False)
    return (x - m) / torch.sqrt(v + eps)
def _scatter_add(tgt, idx, src, axis=0):
    return tgt.clone().index_add_(axis, idx, src)
def _segment_sum(src, seg, n):
    out = torch.zeros((n,) + src.shape[1:], dtype=src.dtype)
    return out.index_add_(0, seg, src)
def _pad(x, pw):
    flat = tuple(v for pair in reversed(pw) for v in pair)
    return torch.nn.functional.pad(x, flat)

kernel_name = 'interleave_layers__sliding_block_cached__geglu_ffn__decode'

def setup_inputs():

    _w = (lambda a: (lambda t: t.to(torch.bfloat16) if t.is_floating_point() else t)(torch.as_tensor(a)))
    def _A_setup():
        B, Sq, D = 4, 1, 512
        Hq, Hkv, Sk, Dh = 32, 32, 4096, 128
        assert Hq % Hkv == 0, (Hq, Hkv)
        return {
            "x": _w((lambda *s: torch.randn(*s, dtype=torch.bfloat16) * 0.05)(B, Sq, D)),
            "k_cache": _w((lambda *s: torch.randn(*s, dtype=torch.bfloat16) * 1.6)(B, Hkv, Sk, Dh)),
            "v_cache": _w((lambda *s: torch.randn(*s, dtype=torch.bfloat16) * 1.6)(B, Hkv, Sk, Dh)),
            "wq": _w((lambda *s: torch.randn(*s, dtype=torch.bfloat16) * 1.6)(D, Hq * Dh) * (D ** -0.5)),
            "wo": _w((lambda *s: torch.randn(*s, dtype=torch.bfloat16) * 1.6)(Hq * Dh, D) * ((Hq * Dh) ** -0.5)),
        }
    _A_in = _A_setup()

    def _B_setup():
        B, S, D, F = 4, 1, 512, 1376
        return {
            "x": _w((lambda *s: torch.randn(*s, dtype=torch.bfloat16) * 0.05)(B, S, D)),
            "w_gate": _w((lambda *s: torch.randn(*s, dtype=torch.bfloat16) * 0.05)(D, F)),
            "w_up": _w((lambda *s: torch.randn(*s, dtype=torch.bfloat16) * 0.05)(D, F)),
            "w_down": _w((lambda *s: torch.randn(*s, dtype=torch.bfloat16) * 0.05)(F, D)),
        }
    _B_in = _B_setup()

    return {
        "A_x": _A_in["x"],
        "A_k_cache": _A_in["k_cache"],
        "A_v_cache": _A_in["v_cache"],
        "A_wq": _A_in["wq"],
        "A_wo": _A_in["wo"],
        "B_x": _B_in["x"],
        "B_w_gate": _B_in["w_gate"],
        "B_w_up": _B_in["w_up"],
        "B_w_down": _B_in["w_down"],
    }

def reference(A_x, A_k_cache, A_v_cache, A_wq, A_wo, B_x, B_w_gate, B_w_up, B_w_down):
    def _A_ref(x, k_cache, v_cache, wq, wo):
        B, Sq, D = x.shape
        Hq, Dh = 32, 128
        Hkv, Sk = k_cache.shape[1], k_cache.shape[2]
        W = min(4096, max(256, Sk // 4))
        rep = Hq // Hkv
        q = (lambda x, *d: x.permute(*d))((x @ wq).reshape(B, Sq, Hq, Dh), 0, 2, 1, 3)
        k = (lambda x, n, axis: torch.repeat_interleave(x, n, dim=axis))(k_cache[:, :, Sk - W:, :], rep, axis=1)
        v = (lambda x, n, axis: torch.repeat_interleave(x, n, dim=axis))(v_cache[:, :, Sk - W:, :], rep, axis=1)
        scores = torch.einsum("bhqd,bhkd->bhqk", q, k) * (Dh ** -0.5)
        p = _softmax(scores, axis=-1)
        o = torch.einsum("bhqk,bhkd->bhqd", p, v)
        return (lambda x, *d: x.permute(*d))(o, 0, 2, 1, 3).reshape(B, Sq, Hq * Dh) @ wo

    def _B_ref(x, w_gate, w_up, w_down):
        return (_gelu(x @ w_gate) * (x @ w_up)) @ w_down

    x = A_x
    x = x + _A_ref(_layernorm(x, axis=-1), A_k_cache, A_v_cache, A_wq, A_wo)
    x = x + _B_ref(_layernorm(x, axis=-1), B_w_gate, B_w_up, B_w_down)
    x = x + _A_ref(_layernorm(x, axis=-1), A_k_cache, A_v_cache, A_wq, A_wo)
    x = x + _B_ref(_layernorm(x, axis=-1), B_w_gate, B_w_up, B_w_down)
    return x
```

```asm
; @launch grid=(256,1,1) block=(512,1,1) lds=61952
.amdgcn_target "amdgcn-amd-amdhsa--gfx950"
.text
.globl interleave_layers__sliding_block_cached__geglu_ffn__decode_kernel
.p2align 8
.type interleave_layers__sliding_block_cached__geglu_ffn__decode_kernel,@function
interleave_layers__sliding_block_cached__geglu_ffn__decode_kernel:
    s_cmp_ge_u32 s2, 256
    s_cbranch_scc1 L_end
    s_load_dwordx16 s[4:19], s[0:1], 0
    s_load_dwordx8 s[20:27], s[0:1], 64
    v_readfirstlane_b32 s72, v0
    s_and_b32 s68, s2, 7
    s_bfe_u32 s70, s2, 0x20003
    s_lshl2_add_u32 s74, s68, s70
    s_lshr_b32 s72, s72, 6
    s_and_b32 s77, s2, 0x60
    s_add_u32 s77, s77, s74
    s_lshr_b32 s78, s2, 7
    s_lshr_b32 s79, s72, 2
    s_lshl1_add_u32 s78, s78, s79
    s_lshl4_add_u32 s77, s77, s78
    s_add_u32 s77, s77, 12
    s_lshl_b32 s77, s77, 16
    s_and_b32 s80, s72, 3
    s_lshl_b32 s3, s80, 12
    v_and_b32 v2, 15, v0
    v_mul_u32_u24 v4, 0x410, v2
    v_mul_u32_u24 v5, 0x1040, v2
    v_and_b32 v4, 0x810, v4
    v_and_b32 v5, 0x8100, v5
    v_bfe_u32 v3, v0, 4, 2
    v_lshl_add_u32 v4, v3, 5, v4
    v_add_u32 v44, v4, v5
    s_mov_b32 s30, 0x10000
    s_mov_b32 s31, 0x20000
    s_cmp_ge_u32 s72, 4
    s_cbranch_scc1 L_late0
    s_waitcnt lgkmcnt(0)
    s_add_u32 s28, s6, s77
    s_addc_u32 s29, s7, 0
    buffer_load_dwordx4 a[0:3], v44, s[28:31], s3 offen offset:0 nt
    buffer_load_dwordx4 a[4:7], v44, s[28:31], s3 offen offset:128 nt
    buffer_load_dwordx4 a[8:11], v44, s[28:31], s3 offen offset:512 nt
    buffer_load_dwordx4 a[12:15], v44, s[28:31], s3 offen offset:640 nt
    buffer_load_dwordx4 a[32:35], v44, s[28:31], s3 offen offset:1024 nt
    buffer_load_dwordx4 a[36:39], v44, s[28:31], s3 offen offset:1152 nt
    s_branch L_early0
L_late0:
    s_getpc_b64 s[32:33]
L_pcref:
    s_lshr_b32 s34, s2, 3
    s_mul_i32 s34, s34, 384
    v_lshl_add_u32 v4, v2, 7, s34
    v_min_u32 v4, L_end-L_pcref, v4
    v_cmp_gt_u32 vcc, 259, v0
    s_nop 0
    s_and_saveexec_b64 s[34:35], vcc
    s_cbranch_execz L_nopf
    global_load_dword v40, v4, s[32:33]
L_nopf:
    s_mov_b64 exec, -1
    v_lshlrev_b32 v4, 2, v2
    v_mov_b32 v5, 0
    ds_write_b32 v4, v5 offset:56768
    v_and_b32 v1, 63, v0
    v_lshlrev_b32 v140, 4, v1
    v_lshlrev_b32 v4, 13, v3
    v_lshl_add_u32 v46, v2, 4, v4
    s_mov_b32 s38, 0x400000
    s_mov_b32 s39, 0x20000
    s_mov_b32 s62, 4096
    s_mov_b32 s63, 0x20000
    s_lshr_b32 s78, s2, 5
    s_lshl2_add_u32 s78, s78, s80
    s_lshl_b32 s78, s78, 17
    s_lshl_b32 s79, s74, 8
    s_add_u32 s78, s78, s79
    s_mov_b32 m0, s3
    s_lshl_b32 s80, s80, 10
    s_waitcnt lgkmcnt(0)
    s_mov_b32 s60, s4
    s_mov_b32 s61, s5
    s_mov_b32 s36, s10
    s_mov_b32 s37, s11
    buffer_load_dwordx4 v[16:19], v140, s[60:63], s80 offen
    buffer_load_dwordx4 v46, s[36:39], s78 offen nt lds
    s_add_u32 m0, s3, 1024
    s_add_u32 s78, s78, 32768
    buffer_load_dwordx4 v46, s[36:39], s78 offen nt lds
    s_add_u32 m0, s3, 2048
    s_add_u32 s78, s78, 32768
    buffer_load_dwordx4 v46, s[36:39], s78 offen nt lds
    s_add_u32 m0, s3, 3072
    s_add_u32 s78, s78, 32768
    buffer_load_dwordx4 v46, s[36:39], s78 offen nt lds
    s_barrier
    s_add_u32 s28, s6, s77
    s_addc_u32 s29, s7, 0
    s_load_dword s88, s[26:27], 0
    s_add_u32 s32, s8, s77
    s_addc_u32 s33, s9, 0
    s_mov_b32 s34, 0x10000
    s_mov_b32 s35, 0x20000
    s_lshr_b32 s69, s2, 3
    s_lshr_b32 s71, s2, 5
    s_and_b32 s73, s71, 3
    s_getreg_b32 s86, hwreg(HW_REG_XCC_ID)
    s_and_b32 s86, s86, 15
    s_mov_b32 s81, 0
    s_branch L_common
L_early0:
    s_load_dword s88, s[26:27], 0
    s_add_u32 s32, s8, s77
    s_addc_u32 s33, s9, 0
    s_mov_b32 s34, 0x10000
    s_mov_b32 s35, 0x20000
    s_lshr_b32 s69, s2, 3
    s_lshr_b32 s71, s2, 5
    s_and_b32 s73, s71, 3
    s_getreg_b32 s86, hwreg(HW_REG_XCC_ID)
    s_and_b32 s86, s86, 15
    s_mov_b32 s81, 0
    v_and_b32 v1, 63, v0
    v_lshlrev_b32 v140, 4, v1
    v_mov_b32 v46, 2147418112
    s_barrier
    s_lshr_b32 s77, 95, s86
    s_and_b32 s77, s77, 1
    s_cselect_b64 vcc, -1, 0
    s_cbranch_vccz L_w1
    s_waitcnt vmcnt(5)
L_w1:
    buffer_load_dwordx4 a[40:43], v44, s[28:31], s3 offen offset:1536 nt
    s_cbranch_vccz L_w2
    s_waitcnt vmcnt(5)
L_w2:
    buffer_load_dwordx4 a[44:47], v44, s[28:31], s3 offen offset:1664 nt
    s_xor_b32 s3, s3, 16384
    s_waitcnt vmcnt(7)
    s_cbranch_vccz L_w3
    s_waitcnt vmcnt(5)
L_w3:
    buffer_load_dwordx4 a[16:19], v44, s[28:31], s3 offen offset:0 nt
    s_waitcnt vmcnt(7)
    s_cbranch_vccz L_w4
    s_waitcnt vmcnt(5)
L_w4:
    buffer_load_dwordx4 a[20:23], v44, s[28:31], s3 offen offset:128 nt
    s_waitcnt vmcnt(7)
    s_cbranch_vccz L_w5
    s_waitcnt vmcnt(5)
L_w5:
    buffer_load_dwordx4 a[24:27], v44, s[28:31], s3 offen offset:512 nt
    s_waitcnt vmcnt(7)
    s_cbranch_vccz L_w6
    s_waitcnt vmcnt(5)
L_w6:
    buffer_load_dwordx4 a[28:31], v44, s[28:31], s3 offen offset:640 nt
    s_waitcnt vmcnt(7)
    s_cbranch_vccz L_w7
    s_waitcnt vmcnt(5)
L_w7:
    buffer_load_dwordx4 a[48:51], v44, s[28:31], s3 offen offset:1024 nt
    s_waitcnt vmcnt(7)
    s_cbranch_vccz L_w8
    s_waitcnt vmcnt(5)
L_w8:
    buffer_load_dwordx4 a[52:55], v44, s[28:31], s3 offen offset:1152 nt
    s_waitcnt vmcnt(7)
    s_cbranch_vccz L_w9
    s_waitcnt vmcnt(5)
L_w9:
    buffer_load_dwordx4 a[56:59], v44, s[28:31], s3 offen offset:1536 nt
    s_waitcnt vmcnt(7)
    s_cbranch_vccz L_w10
    s_waitcnt vmcnt(5)
L_w10:
    buffer_load_dwordx4 a[60:63], v44, s[28:31], s3 offen offset:1664 nt
    s_xor_b32 s3, s3, 16384
    s_waitcnt vmcnt(7)
    s_cbranch_vccz L_w11
    s_waitcnt vmcnt(5)
L_w11:
    buffer_load_dwordx4 v[64:67], v140, s[32:35], s3 offen offset:0 nt
    s_waitcnt vmcnt(7)
    s_cbranch_vccz L_w12
    s_waitcnt vmcnt(5)
L_w12:
    buffer_load_dwordx4 v[72:75], v140, s[32:35], s3 offen offset:1024 nt
    s_waitcnt vmcnt(7)
    s_cbranch_vccz L_w13
    s_waitcnt vmcnt(5)
L_w13:
    buffer_load_dwordx4 v[80:83], v140, s[32:35], s3 offen offset:2048 nt
    s_waitcnt vmcnt(7)
    s_cbranch_vccz L_w14
    s_waitcnt vmcnt(5)
L_w14:
    buffer_load_dwordx4 v[88:91], v140, s[32:35], s3 offen offset:3072 nt
    s_xor_b32 s3, s3, 16384
    s_waitcnt vmcnt(7)
    s_cbranch_vccz L_w15
    s_waitcnt vmcnt(5)
L_w15:
    buffer_load_dwordx4 v[68:71], v140, s[32:35], s3 offen offset:0 nt
    s_waitcnt vmcnt(7)
    s_cbranch_vccz L_w16
    s_waitcnt vmcnt(5)
L_w16:
    buffer_load_dwordx4 v[76:79], v140, s[32:35], s3 offen offset:1024 nt
    s_waitcnt vmcnt(7)
    s_cbranch_vccz L_w17
    s_waitcnt vmcnt(5)
L_w17:
    buffer_load_dwordx4 v[84:87], v140, s[32:35], s3 offen offset:2048 nt
    s_waitcnt vmcnt(7)
    s_cbranch_vccz L_w18
    s_waitcnt vmcnt(5)
L_w18:
    buffer_load_dwordx4 v[92:95], v140, s[32:35], s3 offen offset:3072 nt
    s_xor_b32 s3, s3, 49152
    s_waitcnt vmcnt(7)
    s_cbranch_vccz L_w19
    s_waitcnt vmcnt(5)
L_w19:
    buffer_load_dwordx4 v[96:99], v140, s[32:35], s3 offen offset:0 nt
    s_waitcnt vmcnt(7)
    s_cbranch_vccz L_w20
    s_waitcnt vmcnt(5)
L_w20:
    buffer_load_dwordx4 v[104:107], v140, s[32:35], s3 offen offset:1024 nt
    s_waitcnt vmcnt(7)
    s_cbranch_vccz L_w21
    s_waitcnt vmcnt(5)
L_w21:
    buffer_load_dwordx4 v[112:115], v140, s[32:35], s3 offen offset:2048 nt
    s_waitcnt vmcnt(7)
    s_cbranch_vccz L_w22
    s_waitcnt vmcnt(5)
L_w22:
    buffer_load_dwordx4 v[120:123], v140, s[32:35], s3 offen offset:3072 nt
    s_xor_b32 s3, s3, 16384
    s_waitcnt vmcnt(7)
    s_cbranch_vccz L_w23
    s_waitcnt vmcnt(5)
L_w23:
    buffer_load_dwordx4 v[100:103], v140, s[32:35], s3 offen offset:0 nt
    s_waitcnt vmcnt(7)
    s_cbranch_vccz L_w24
    s_waitcnt vmcnt(5)
L_w24:
    buffer_load_dwordx4 v[108:111], v140, s[32:35], s3 offen offset:1024 nt
    s_waitcnt vmcnt(7)
    s_cbranch_vccz L_w25
    s_waitcnt vmcnt(5)
L_w25:
    buffer_load_dwordx4 v[116:119], v140, s[32:35], s3 offen offset:2048 nt
    s_waitcnt vmcnt(7)
    s_cbranch_vccz L_w26
    s_waitcnt vmcnt(5)
L_w26:
    buffer_load_dwordx4 v[124:127], v140, s[32:35], s3 offen offset:3072 nt
    s_waitcnt vmcnt(3)
    s_and_b32 s77, s72, 3
    s_lshl_b32 s77, s77, 2
    v_mov_b32 v38, s77
    v_mov_b32 v39, 1
    ds_write_b32 v38, v39 offset:56784
L_common:
    s_mov_b32 s43, 0x20000
    s_mov_b32 s47, 0x20000
    s_mov_b32 s51, 0x20000
    s_mov_b32 s55, 0x20000
    s_mov_b32 s59, 0x20000
    s_mov_b32 s67, 0x20000
    s_mov_b32 s56, s26
    s_mov_b32 s57, s27
    s_mov_b32 s58, 2183168
    s_mul_i32 s75, s2, 3712
    s_add_u32 s75, s75, 1232896
    s_and_b32 s77, s2, 31
    s_mul_i32 s76, s77, 3200
    s_add_u32 s76, s76, 1130496
    s_lshl_b32 s90, s71, 15
    s_lshl_b32 s77, s77, 7
    s_add_u32 s90, s90, s77
    v_mov_b32 v7, 2147418112
    v_lshrrev_b32 v9, 3, v1
    v_and_b32 v10, 7, v1
    v_lshlrev_b32 v141, 24, v1
    v_and_b32 v4, 32, v1
    v_lshlrev_b32 v4, 8, v4
    v_and_b32 v5, 8, v1
    v_lshl_add_u32 v4, v5, 9, v4
    v_and_b32 v5, 16, v1
    v_lshl_add_u32 v4, v5, 10, v4
    v_lshl_add_u32 v45, v10, 4, v4
    s_mov_b32 s89, 0
    s_waitcnt lgkmcnt(0)
    s_add_u32 s88, s88, 1
    s_and_b32 s77, s88, 0xff
    s_cselect_b32 s77, 0, 1
    s_add_u32 s88, s88, s77
    s_cmp_lt_u32 s72, 4
    s_cbranch_scc1 L_part2
    s_cmp_eq_u32 s72, 7
    s_cbranch_scc0 L_w727
    s_and_b32 s78, s88, 0x0fffffff
    s_lshl_b32 s79, s86, 28
    s_or_b32 s83, s78, s79
    v_mov_b32 v34, s83
    s_lshl_b32 s77, s71, 2
    s_add_u32 s77, s77, s76
    buffer_store_dword v34, v141, s[56:59], s77 offen offset:2944 sc1
    v_mov_b32 v28, -1
    v_mov_b32 v29, -1
    v_mov_b32 v30, -1
    v_mov_b32 v31, -1
    s_add_u32 s77, s90, 16384
    buffer_store_dwordx4 v[28:31], v45, s[56:59], s77 offen sc1
    s_mul_i32 s78, s71, 112
    s_add_u32 s78, s78, s76
    s_add_u32 s10, s26, s78
    s_addc_u32 s11, s27, 0
    s_load_dword s4, s[10:11], 2048
    s_load_dword s4, s[10:11], 2104
    s_load_dword s4, s[10:11], 2156
L_w727:
    s_cmp_eq_u32 s72, 5
    s_cbranch_scc0 L_w528
    s_lshl_b32 s77, s71, 8
    s_add_u32 s77, s77, s76
    s_add_u32 s8, s26, s77
    s_addc_u32 s9, s27, 0
    s_load_dword s4, s[8:9], 0
    s_load_dword s4, s[8:9], 64
    s_load_dword s4, s[8:9], 128
    s_load_dword s4, s[8:9], 192
L_w528:
    s_and_b32 s77, s72, 3
    s_mul_i32 s77, s77, 640
    s_add_u32 s77, s77, s75
    s_add_u32 s6, s26, s77
    s_addc_u32 s7, s27, 0
    s_load_dword s5, s[6:7], 0
    s_load_dword s5, s[6:7], 64
    s_load_dword s5, s[6:7], 128
    s_load_dword s5, s[6:7], 192
    s_load_dword s5, s[6:7], 256
    s_load_dword s5, s[6:7], 320
    s_load_dword s5, s[6:7], 384
    s_load_dword s5, s[6:7], 448
    s_load_dword s5, s[6:7], 512
    s_load_dword s5, s[6:7], 576
L_part2:
    s_mov_b32 s40, s12
    s_mov_b32 s41, s13
    s_mov_b32 s42, 0x400000
    s_mov_b32 s44, s16
    s_mov_b32 s45, s17
    s_mov_b32 s46, 1409024
    s_mov_b32 s48, s18
    s_mov_b32 s49, s19
    s_mov_b32 s50, 1409024
    s_mul_i32 s85, s68, 11
    s_cmp_eq_u32 s68, 7
    s_cselect_b32 s85, 76, s85
    s_cmp_lt_u32 s68, 6
    s_cselect_b32 s84, 11, 10
    s_mul_i32 s77, s70, 3
    s_add_u32 s85, s85, s77
    s_sub_u32 s84, s84, s77
    s_min_u32 s84, s84, 3
    s_add_u32 s77, s85, s84
    s_lshl_b32 s54, s77, 14
    s_mov_b32 s52, s20
    s_mov_b32 s53, s21
    s_mov_b32 s64, s22
    s_mov_b32 s65, s23
    s_mov_b32 s66, 4096
    s_xor_b32 s87, s68, s71
    s_mov_b64 s[12:13], 0xf0002
    s_mov_b64 s[14:15], 12
    s_mov_b64 s[16:17], 8
    s_lshl_b32 s91, s85, 5
    s_mul_i32 s78, s71, 176128
    s_add_u32 s91, s91, s78
    s_lshl_b32 s92, s85, 14
    s_lshl_b32 s78, s72, 13
    s_add_u32 s92, s92, s78
    s_lshl_b32 s78, s71, 7
    s_add_u32 s92, s92, s78
    v_lshlrev_b32 v4, 9, v2
    v_lshl_add_u32 v4, v3, 4, v4
    s_lshl_b32 s78, s72, 6
    s_add_u32 s78, s78, s75
    v_add_u32 v4, s78, v4
    v_cmp_gt_u32 vcc, 5, v2
    s_nop 1
    v_cndmask_b32 v43, v7, v4, vcc
    v_cmp_gt_u32 vcc, 4, v2
    s_nop 1
    v_cndmask_b32 v56, v7, v4, vcc
    v_min_u32 v4, 5, v2
    v_mul_u32_u24 v4, 144, v4
    v_lshl_add_u32 v4, v3, 4, v4
    v_add_u32 v128, 53248, v4
    v_lshrrev_b32 v4, 2, v2
    v_lshl_add_u32 v4, v3, 3, v4
    v_and_b32 v5, 3, v2
    s_lshl_b32 s77, s72, 5
    v_lshl_add_u32 v5, v5, 3, s77
    v_lshl_add_u32 v42, v4, 8, v5
    v_lshl_add_u32 v139, v4, 7, v5
    v_and_b32 v4, 24, v1
    v_lshlrev_b32 v4, 2, v4
    v_xor_b32 v139, v139, v4
    v_lshrrev_b32 v4, 1, v3
    v_and_b32 v5, 1, v3
    v_lshl_add_u32 v8, v5, 1, v4
    s_and_b32 s78, s72, 3
    s_lshl_b32 s78, s78, 5
    v_and_b32 v4, 4, v2
    v_add_u32 v4, v4, v3
    v_lshl_add_u32 v5, v4, 2, s78
    v_and_b32 v4, 3, v2
    v_mul_u32_u24 v6, 144, v4
    v_add_u32 v6, v5, v6
    v_add_u32 v61, 53248, v6
    v_and_b32 v4, 11, v2
    v_lshl_add_u32 v4, v4, 10, v5
    s_lshl_b32 s77, s71, 7
    v_add_u32 v0, s77, v4
    s_lshl_b32 s78, s72, 5
    s_add_u32 s78, s78, 54784
    v_lshl_add_u32 v5, v2, 1, s78
    v_mul_u32_u24 v6, 144, v8
    v_add_u32 v135, v5, v6
    v_add_u32 v6, 55712, v140
    s_and_b32 s77, s2, 31
    s_mul_i32 s77, s77, 3712
    s_add_u32 s77, s77, 1232896
    s_mov_b32 s80, 118784
    v_mul_lo_u32 v4, v9, s80
    v_add_u32 v11, s77, v4
    s_lshl_b32 s78, s72, 7
    v_lshl_add_u32 v4, v10, 4, v11
    v_add_u32 v48, s78, v4
    s_lshl_b32 s78, s72, 6
    v_and_b32 v4, 4, v1
    v_lshl_add_u32 v4, v4, 2, v11
    v_and_b32 v5, 2, v1
    v_lshl_add_u32 v4, v5, 4, v4
    v_add_u32 v54, s78, v4
    v_mov_b32 v53, v7
    v_lshl_add_u32 v4, v10, 3, s76
    v_lshl_add_u32 v55, v8, 6, v4
    s_lshl_b32 s77, s73, 6
    v_add_u32 v49, s77, v4
    v_lshrrev_b32 v4, 3, v2
    v_lshl_add_u32 v4, v4, 2, v3
    v_lshlrev_b32 v4, 7, v4
    v_lshl_add_u32 v4, v10, 4, v4
    v_add_u32 v50, s76, v4
    v_lshl_add_u32 v4, v10, 2, s76
    v_cmp_gt_u32 vcc, 8, v2
    s_nop 1
    v_cndmask_b32 v51, v7, v4, vcc
    s_and_b32 s77, s72, 1
    s_lshl_b32 s77, s77, 12
    s_and_b32 s78, s72, 2
    s_lshl_b32 s78, s78, 13
    s_add_u32 s77, s77, s78
    s_lshl_b32 s78, s71, 15
    s_add_u32 s78, s78, s77
    v_add_u32 v52, s78, v140
    s_add_u32 s77, s77, s90
    v_and_b32 v4, 2, v3
    v_lshlrev_b32 v4, 5, v4
    v_and_b32 v5, 1, v3
    v_lshl_add_u32 v4, v5, 3, v4
    v_add_u32 v4, s77, v4
    v_and_b32 v5, 3, v2
    v_lshl_add_u32 v5, v5, 4, v4
    v_and_b32 v11, 4, v2
    v_lshl_add_u32 v5, v11, 11, v5
    v_cndmask_b32 v60, v7, v5, vcc
    v_and_b32 v5, 6, v2
    v_lshl_add_u32 v5, v5, 3, v4
    v_and_b32 v11, 1, v2
    v_lshl_add_u32 v5, v11, 13, v5
    v_cndmask_b32 v59, v7, v5, vcc
    v_and_b32 v4, 2, v1
    v_lshlrev_b32 v4, 4, v4
    v_and_b32 v5, 1, v8
    v_lshl_add_u32 v4, v5, 4, v4
    v_and_b32 v5, 4, v1
    v_lshl_add_u32 v4, v5, 1, v4
    v_and_b32 v5, 1, v1
    v_lshl_add_u32 v4, v5, 2, v4
    v_and_b32 v5, 2, v8
    s_lshl_b32 s77, s72, 6
    s_add_u32 s77, s77, 55424
    v_add3_u32 v4, v4, v5, s77
    v_cndmask_b32 v129, v6, v4, vcc
    s_and_b32 s77, s72, 6
    s_lshl_b32 s77, s77, 1
    s_and_b32 s78, s72, 1
    s_add_u32 s77, s77, s78
    v_and_b32 v4, 2, v3
    v_add_u32 v4, s77, v4
    s_add_u32 s77, s75, 2560
    v_and_b32 v5, 1, v3
    v_lshl_add_u32 v5, v5, 3, s77
    v_lshl_add_u32 v11, v4, 4, v5
    v_add_u32 v11, 768, v11
    v_lshl_add_u32 v4, v4, 6, v5
    v_lshl_add_u32 v4, v2, 4, v4
    v_cmp_gt_u32 vcc, 4, v2
    s_nop 1
    v_cndmask_b32 v4, v11, v4, vcc
    v_cmp_gt_u32 vcc, 5, v2
    s_nop 1
    v_cndmask_b32 v57, v7, v4, vcc
    s_lshr_b32 s78, s71, 2
    s_lshl_b32 s77, s73, 1
    s_add_u32 s77, s77, s78
    s_lshl_b32 s93, s77, 2
    s_add_u32 s93, s93, s76
    v_and_b32 v4, 3, v2
    v_mul_u32_u24 v5, 144, v4
    v_lshl_add_u32 v5, v3, 4, v5
    v_add_u32 v136, 54784, v5
    v_lshlrev_b32 v4, 4, v4
    v_lshl_add_u32 v4, v3, 6, v4
    v_add_u32 v4, 55424, v4
    v_mov_b32 v5, 55680
    v_lshrrev_b32 v11, 2, v2
    v_cmp_eq_u32 vcc, 0, v11
    s_nop 1
    v_cndmask_b32 v130, v5, v4, vcc
    v_cmp_eq_u32 vcc, 1, v11
    s_nop 1
    v_cndmask_b32 v131, v5, v4, vcc
    v_cmp_eq_u32 vcc, 2, v11
    s_nop 1
    v_cndmask_b32 v132, v5, v4, vcc
    v_cmp_eq_u32 vcc, 3, v11
    s_nop 1
    v_cndmask_b32 v133, v5, v4, vcc
    s_mul_i32 s77, s72, 608
    s_add_u32 s77, s77, 56896
    v_lshl_add_u32 v4, v2, 3, s77
    v_lshlrev_b32 v5, 3, v2
    v_add_u32 v5, 55712, v5
    v_cmp_gt_u32 vcc, 16, v1
    s_nop 1
    v_cndmask_b32 v134, v5, v4, vcc
    s_lshl_b32 s77, s72, 3
    s_add_u32 s77, s77, 61760
    v_lshlrev_b32 v4, 3, v1
    v_add_u32 v142, 55712, v4
    v_writelane_b32 v142, s77, 63
    v_and_b32 v4, 1, v1
    v_mul_u32_u24 v5, 0x5555, v4
    v_add_u32 v138, 0x8888, v5
    v_lshlrev_b32 v4, 4, v4
    v_mov_b32 v5, 0x3f80
    v_lshlrev_b32 v4, v4, v5
    v_lshrrev_b32 v5, 1, v10
    v_cmp_eq_u32 vcc, 0, v5
    s_nop 1
    v_cndmask_b32 v6, 0, v4, vcc
    v_accvgpr_write_b32 a104, v6
    v_cmp_eq_u32 vcc, 1, v5
    s_nop 1
    v_cndmask_b32 v6, 0, v4, vcc
    v_accvgpr_write_b32 a105, v6
    v_cmp_eq_u32 vcc, 2, v5
    s_nop 1
    v_cndmask_b32 v6, 0, v4, vcc
    v_accvgpr_write_b32 a106, v6
    v_cmp_eq_u32 vcc, 3, v5
    s_nop 1
    v_cndmask_b32 v6, 0, v4, vcc
    v_accvgpr_write_b32 a107, v6
    v_cmp_eq_u32 vcc, 0, v11
    s_nop 1
    v_cndmask_b32 v6, 0, v4, vcc
    v_accvgpr_write_b32 a108, v6
    v_cmp_eq_u32 vcc, 1, v11
    s_nop 1
    v_cndmask_b32 v6, 0, v4, vcc
    v_accvgpr_write_b32 a109, v6
    v_cmp_eq_u32 vcc, 2, v11
    s_nop 1
    v_cndmask_b32 v6, 0, v4, vcc
    v_accvgpr_write_b32 a110, v6
    v_cmp_eq_u32 vcc, 3, v11
    s_nop 1
    v_cndmask_b32 v6, 0, v4, vcc
    v_accvgpr_write_b32 a111, v6
    v_lshlrev_b32 v4, 10, v9
    v_lshl_add_u32 v63, v10, 4, v4
    v_and_b32 v4, 16, v1
    v_lshlrev_b32 v4, 1, v4
    v_xor_b32 v63, v63, v4
    s_cmp_lt_u32 s72, 4
    s_cbranch_scc1 L_early1
    s_and_b32 s77, s72, 3
    s_lshl_b32 s77, s77, 6
    v_add_u32 v4, s77, v1
    v_mul_u32_u24 v5, 43691, v4
    v_lshrrev_b32 v5, 18, v5
    v_mul_u32_u24 v6, 6, v5
    v_sub_u32 v4, v4, v6
    v_mul_u32_u24 v5, 2752, v5
    v_lshl_add_u32 v5, v4, 4, v5
    s_lshl_b32 s77, s84, 1
    v_cmp_gt_u32 vcc, s77, v4
    s_nop 1
    v_cndmask_b32 v49, v7, v5, vcc
    s_lshl_b32 s77, s71, 3
    s_add_u32 s77, s77, s76
    v_lshlrev_b32 v4, 6, v2
    v_lshl_add_u32 v4, v3, 2, v4
    v_add_u32 v4, s77, v4
    v_and_b32 v5, 0x2c, v1
    v_cmp_eq_u32 vcc, 0, v5
    s_nop 1
    v_cndmask_b32 v53, v7, v4, vcc
    s_cmp_eq_u32 s72, 6
    s_cbranch_scc0 L_w629
    v_mov_b32 v4, 0x3f803f80
    v_and_b32 v5, 31, v1
    v_lshlrev_b32 v5, 2, v5
    ds_write_b32 v5, v4 offset:53824
    v_mov_b32 v4, 0x3b003b00
    ds_write_b32 v5, v4 offset:53968
    v_mov_b32 v6, 0
    v_and_b32 v4, 12, v5
    ds_write_b32 v4, v6 offset:55680
    v_mul_u32_u24 v4, 144, v3
    v_lshl_add_u32 v4, v10, 2, v4
    ds_write_b32 v4, v6 offset:54880
L_w629:
    v_mov_b32 v12, 0
    v_mov_b32 v13, 0
    v_mov_b32 v14, 0x3f803f80
    s_and_b32 s77, s72, 3
    s_mul_i32 s77, s77, 144
    s_add_u32 s77, s77, 53248
    v_lshl_add_u32 v4, v10, 4, s77
    v_mov_b32 v6, 55712
    v_cmp_eq_u32 vcc, s71, v9
    s_nop 1
    v_cndmask_b32 v15, v6, v4, vcc
    s_cmp_lt_u32 s72, 7
    s_cbranch_scc1 L_w0a
    s_add_u32 s22, s26, s76
    s_addc_u32 s23, s27, 0
    s_waitcnt vmcnt(6) lgkmcnt(0)
    s_load_dwordx8 s[4:11], s[22:23], 2944
    s_branch L_w0b
L_w0a:
    s_waitcnt vmcnt(4) lgkmcnt(0)
L_w0b:
    v_dot2_f32_bf16 v12, v16, v16, v12
    v_dot2_f32_bf16 v13, v16, v14, v13
    v_dot2_f32_bf16 v12, v17, v17, v12
    v_dot2_f32_bf16 v13, v17, v14, v13
    v_dot2_f32_bf16 v12, v18, v18, v12
    v_dot2_f32_bf16 v13, v18, v14, v13
    v_dot2_f32_bf16 v12, v19, v19, v12
    v_dot2_f32_bf16 v13, v19, v14, v13
    ds_write_b128 v15, v[16:19] offset:896
    s_nop 1
    v_add_f32_dpp v12, v12, v12 quad_perm:[1,0,3,2] row_mask:0xf bank_mask:0xf
    v_add_f32_dpp v13, v13, v13 quad_perm:[1,0,3,2] row_mask:0xf bank_mask:0xf
    s_nop 0
    v_add_f32_dpp v12, v12, v12 quad_perm:[2,3,0,1] row_mask:0xf bank_mask:0xf
    v_add_f32_dpp v13, v13, v13 quad_perm:[2,3,0,1] row_mask:0xf bank_mask:0xf
    s_nop 0
    v_add_f32_dpp v12, v12, v12 row_half_mirror row_mask:0xf bank_mask:0xf
    v_add_f32_dpp v13, v13, v13 row_half_mirror row_mask:0xf bank_mask:0xf
    s_nop 0
    v_add_f32_dpp v12, v12, v12 row_ror:8 row_mask:0xf bank_mask:0xf
    v_add_f32_dpp v13, v13, v13 row_ror:8 row_mask:0xf bank_mask:0xf
    v_mov_b32 v11, v12
    s_nop 1
    v_permlane16_swap_b32 v12, v11
    v_add_f32 v12, v12, v11
    v_mov_b32 v11, v12
    s_nop 1
    v_permlane32_swap_b32 v12, v11
    v_add_f32 v12, v12, v11
    v_mov_b32 v11, v13
    s_nop 1
    v_permlane16_swap_b32 v13, v11
    v_add_f32 v13, v13, v11
    v_mov_b32 v11, v13
    s_nop 1
    v_permlane32_swap_b32 v13, v11
    v_add_f32 v13, v13, v11
    v_mul_f32 v13, 0x3b000000, v13
    v_mul_f32 v12, 0x3b000000, v12
    v_fma_f32 v12, -v13, v13, v12
    v_max_f32 v12, 0, v12
    v_add_f32 v12, 0x3727c5ac, v12
    v_rsq_f32 v12, v12
    v_lshlrev_b32 v4, 16, v16
    v_and_b32 v5, 0xffff0000, v16
    v_sub_f32 v4, v4, v13
    v_sub_f32 v5, v5, v13
    v_mul_f32 v4, v4, v12
    v_mul_f32 v5, v5, v12
    v_cvt_pk_bf16_f32 v20, v4, v5
    v_lshlrev_b32 v4, 16, v17
    v_and_b32 v5, 0xffff0000, v17
    v_sub_f32 v4, v4, v13
    v_sub_f32 v5, v5, v13
    v_mul_f32 v4, v4, v12
    v_mul_f32 v5, v5, v12
    v_cvt_pk_bf16_f32 v21, v4, v5
    v_lshlrev_b32 v4, 16, v18
    v_and_b32 v5, 0xffff0000, v18
    v_sub_f32 v4, v4, v13
    v_sub_f32 v5, v5, v13
    v_mul_f32 v4, v4, v12
    v_mul_f32 v5, v5, v12
    v_cvt_pk_bf16_f32 v22, v4, v5
    v_lshlrev_b32 v4, 16, v19
    v_and_b32 v5, 0xffff0000, v19
    v_sub_f32 v4, v4, v13
    v_sub_f32 v5, v5, v13
    v_mul_f32 v4, v4, v12
    v_mul_f32 v5, v5, v12
    v_cvt_pk_bf16_f32 v23, v4, v5
    ds_write_b128 v15, v[20:23]
    s_cmp_eq_u32 s72, 7
    s_cbranch_scc0 L_w7m30
    s_lshl_b32 s77, s71, 8
    s_mul_i32 s78, s71, 112
    s_add_u32 s78, s78, 1792
    v_add_u32 v4, s77, v140
    v_add_u32 v5, s78, v140
    v_cmp_gt_u32 vcc, 16, v1
    s_nop 1
    v_cndmask_b32 v4, v5, v4, vcc
    v_cmp_gt_u32 vcc, 23, v1
    s_nop 1
    v_cndmask_b32 v35, v7, v4, vcc
    s_waitcnt lgkmcnt(0)
    s_xor_b32 s77, s4, s83
    s_xor_b32 s78, s5, s83
    s_or_b32 s77, s77, s78
    s_xor_b32 s78, s6, s83
    s_or_b32 s77, s77, s78
    s_xor_b32 s78, s7, s83
    s_or_b32 s77, s77, s78
    s_xor_b32 s78, s8, s83
    s_or_b32 s77, s77, s78
    s_xor_b32 s78, s9, s83
    s_or_b32 s77, s77, s78
    s_xor_b32 s78, s10, s83
    s_or_b32 s77, s77, s78
    s_xor_b32 s78, s11, s83
    s_or_b32 s77, s77, s78
    s_and_b32 s78, s77, 0x0fffffff
    s_cbranch_scc0 L_mf31k
    v_lshlrev_b32 v4, 2, v10
L_mf31:
    buffer_load_dword v5, v4, s[56:59], s76 offen offset:2944 sc1
    s_add_u32 s81, s81, 1
    s_cmp_gt_u32 s81, 4000000
    s_cbranch_scc1 L_end
    s_waitcnt vmcnt(0)
    v_xor_b32 v5, s83, v5
    v_and_b32 v6, 0x0fffffff, v5
    v_cmp_ne_u32 vcc, 0, v6
    s_cbranch_vccnz L_mf31
    v_cmp_ne_u32 vcc, 0, v5
    s_nop 1
    s_mov_b32 s77, vcc_lo
L_mf31k:
    s_cmp_eq_u32 s77, 0
    s_cselect_b32 s89, 1, 0
    s_cmp_eq_u32 s89, 0
    s_cbranch_scc1 L_sc1_32
    buffer_store_dwordx4 v[28:31], v35, s[56:59], s76 offen
L_sc1_32r:
    s_waitcnt vmcnt(1)
    s_branch L_w1b
L_w7m30:
    s_waitcnt vmcnt(0)
L_w1b:
    s_add_u32 s78, s89, 1
    s_and_b32 s77, s72, 3
    s_lshl_b32 s77, s77, 2
    v_mov_b32 v38, s77
    v_mov_b32 v39, s78
    ds_write_b32 v38, v39 offset:56768
    s_cmp_eq_u32 s72, 4
    s_cbranch_scc0 L_race33
    s_lshr_b32 s77, s2, 6
    s_lshl_b32 s77, s77, 14
    s_and_b32 s78, s2, 63
    s_lshl_b32 s78, s78, 7
    s_add_u32 s77, s77, s78
    s_add_u32 s77, s77, 1064960
    s_and_b32 s79, s70, 1
    s_lshl_b32 s78, s79, 13
    s_add_u32 s77, s77, s78
    s_xor_b32 s78, s77, 8192
    s_waitcnt lgkmcnt(0)
    s_load_dword s4, s[26:27], s77
    s_load_dword s5, s[26:27], s78
    s_waitcnt lgkmcnt(1)
    s_lshr_b32 s78, s86, 2
    s_xor_b32 s79, s79, s78
    s_and_b32 s79, s79, 1
    s_and_b32 s78, s88, 0x0fffffff
    s_getreg_b32 s77, hwreg(HW_REG_IB_STS, 8, 4)
    s_cmp_eq_u32 s77, 0
    s_cselect_b32 s77, 1, 0
    s_xor_b32 s77, s77, s79
    s_lshl_b32 s77, s77, 28
    s_or_b32 s77, s77, s78
    v_mov_b32 v34, s77
L_race33:
    v_mov_b32 v38, 0
L_lds34:
    ds_read_b128 v[24:27], v38 offset:56768
    s_add_u32 s81, s81, 1
    s_cmp_gt_u32 s81, 4000000
    s_cbranch_scc1 L_end
    s_waitcnt lgkmcnt(0)
    v_min3_u32 v39, v24, v25, v26
    v_min_u32 v39, v39, v27
    v_cmp_eq_u32 vcc, 0, v39
    s_cbranch_vccnz L_lds34
    v_readfirstlane_b32 s89, v27
    s_nop 0
    s_sub_u32 s89, s89, 1
    s_cmp_eq_u32 s72, 4
    s_cbranch_scc0 L_gf35
    s_lshl_b32 s77, s71, 2
    s_add_u32 s77, s77, s76
    buffer_store_dword v34, v141, s[56:59], s77 offen offset:3072 sc1
L_gf35:
    ds_read_b128 v[4:7], v128
    ds_read_b128 v[8:11], v128 offset:64
    v_subrev_u32 v32, 128, v42
    ds_read_b64_tr_b16 a[64:65], v42 offset:0
    ds_read_b64_tr_b16 a[66:67], v42 offset:1024
    ds_read_b64_tr_b16 a[68:69], v42 offset:8192
    ds_read_b64_tr_b16 a[70:71], v42 offset:9216
    ds_read_b64_tr_b16 v[24:25], v32 offset:0
    ds_read_b64_tr_b16 v[26:27], v32 offset:1024
    ds_read_b64_tr_b16 v[28:29], v32 offset:8192
    ds_read_b64_tr_b16 v[30:31], v32 offset:9216
    s_movk_i32 s79, 0xff
    v_mov_b32 v20, s88
    v_subrev_u32 v33, 256, v43
    s_waitcnt lgkmcnt(0)
    v_mfma_f32_16x16x32_bf16 v[12:15], a[64:67], v[4:7], 0
    v_mfma_f32_16x16x32_bf16 v[16:19], v[24:27], v[4:7], 0
    v_mfma_f32_16x16x32_bf16 v[12:15], a[68:71], v[8:11], v[12:15]
    v_mfma_f32_16x16x32_bf16 v[16:19], v[28:31], v[8:11], v[16:19]
    s_nop 6
    v_bfi_b32 v12, s79, v20, v12
    v_bfi_b32 v13, s79, v20, v13
    v_bfi_b32 v14, s79, v20, v14
    v_bfi_b32 v15, s79, v20, v15
    v_bfi_b32 v16, s79, v20, v16
    v_bfi_b32 v17, s79, v20, v17
    v_bfi_b32 v18, s79, v20, v18
    v_bfi_b32 v19, s79, v20, v19
    s_cmp_eq_u32 s72, 7
    s_cbranch_scc0 L_hack36
    s_waitcnt vmcnt(0)
L_hack36:
    s_cmp_eq_u32 s89, 0
    s_cbranch_scc1 L_sc1_37
    buffer_store_dwordx4 v[12:15], v43, s[56:59], 0 offen
    buffer_store_dwordx4 v[16:19], v33, s[56:59], 0 offen
L_sc1_37r:
    s_and_b32 s77, s72, 3
    s_lshl_b32 s77, s77, 2
    v_mov_b32 v38, s77
L_hand38:
    ds_read_b32 v39, v38 offset:56784
    s_add_u32 s81, s81, 1
    s_cmp_gt_u32 s81, 4000000
    s_cbranch_scc1 L_end
    s_waitcnt lgkmcnt(0)
    v_cmp_eq_u32 vcc, 0, v39
    s_cbranch_vccnz L_hand38
    buffer_load_dwordx4 a[0:3], v44, s[28:31], s3 offen offset:0 nt
    buffer_load_dwordx4 a[4:7], v44, s[28:31], s3 offen offset:128 nt
    buffer_load_dwordx4 a[8:11], v44, s[28:31], s3 offen offset:512 nt
    buffer_load_dwordx4 a[12:15], v44, s[28:31], s3 offen offset:640 nt
    buffer_load_dwordx4 a[32:35], v44, s[28:31], s3 offen offset:1024 nt
    buffer_load_dwordx4 a[36:39], v44, s[28:31], s3 offen offset:1152 nt
    s_lshr_b32 s77, 95, s86
    s_and_b32 s77, s77, 1
    s_cselect_b64 vcc, -1, 0
    s_cbranch_vccz L_w39
    s_waitcnt vmcnt(5)
L_w39:
    buffer_load_dwordx4 a[40:43], v44, s[28:31], s3 offen offset:1536 nt
    s_cbranch_vccz L_w40
    s_waitcnt vmcnt(5)
L_w40:
    buffer_load_dwordx4 a[44:47], v44, s[28:31], s3 offen offset:1664 nt
    s_xor_b32 s3, s3, 16384
    s_waitcnt vmcnt(7)
    s_cbranch_vccz L_w41
    s_waitcnt vmcnt(5)
L_w41:
    buffer_load_dwordx4 a[16:19], v44, s[28:31], s3 offen offset:0 nt
    s_waitcnt vmcnt(7)
    s_cbranch_vccz L_w42
    s_waitcnt vmcnt(5)
L_w42:
    buffer_load_dwordx4 a[20:23], v44, s[28:31], s3 offen offset:128 nt
    s_waitcnt vmcnt(7)
    s_cbranch_vccz L_w43
    s_waitcnt vmcnt(5)
L_w43:
    buffer_load_dwordx4 a[24:27], v44, s[28:31], s3 offen offset:512 nt
    s_waitcnt vmcnt(7)
    s_cbranch_vccz L_w44
    s_waitcnt vmcnt(5)
L_w44:
    buffer_load_dwordx4 a[28:31], v44, s[28:31], s3 offen offset:640 nt
    s_waitcnt vmcnt(7)
    s_cbranch_vccz L_w45
    s_waitcnt vmcnt(5)
L_w45:
    buffer_load_dwordx4 a[48:51], v44, s[28:31], s3 offen offset:1024 nt
    s_waitcnt vmcnt(7)
    s_cbranch_vccz L_w46
    s_waitcnt vmcnt(5)
L_w46:
    buffer_load_dwordx4 a[52:55], v44, s[28:31], s3 offen offset:1152 nt
    s_waitcnt vmcnt(7)
    s_cbranch_vccz L_w47
    s_waitcnt vmcnt(5)
L_w47:
    buffer_load_dwordx4 a[56:59], v44, s[28:31], s3 offen offset:1536 nt
    s_waitcnt vmcnt(7)
    s_cbranch_vccz L_w48
    s_waitcnt vmcnt(5)
L_w48:
    buffer_load_dwordx4 a[60:63], v44, s[28:31], s3 offen offset:1664 nt
    s_xor_b32 s3, s3, 16384
    s_waitcnt vmcnt(7)
    s_cbranch_vccz L_w49
    s_waitcnt vmcnt(5)
L_w49:
    buffer_load_dwordx4 v[64:67], v140, s[32:35], s3 offen offset:0 nt
    s_waitcnt vmcnt(7)
    s_cbranch_vccz L_w50
    s_waitcnt vmcnt(5)
L_w50:
    buffer_load_dwordx4 v[72:75], v140, s[32:35], s3 offen offset:1024 nt
    s_waitcnt vmcnt(7)
    s_cbranch_vccz L_w51
    s_waitcnt vmcnt(5)
L_w51:
    buffer_load_dwordx4 v[80:83], v140, s[32:35], s3 offen offset:2048 nt
    s_waitcnt vmcnt(7)
    s_cbranch_vccz L_w52
    s_waitcnt vmcnt(5)
L_w52:
    buffer_load_dwordx4 v[88:91], v140, s[32:35], s3 offen offset:3072 nt
    s_xor_b32 s3, s3, 16384
    s_waitcnt vmcnt(7)
    s_cbranch_vccz L_w53
    s_waitcnt vmcnt(5)
L_w53:
    buffer_load_dwordx4 v[68:71], v140, s[32:35], s3 offen offset:0 nt
    s_waitcnt vmcnt(7)
    s_cbranch_vccz L_w54
    s_waitcnt vmcnt(5)
L_w54:
    buffer_load_dwordx4 v[76:79], v140, s[32:35], s3 offen offset:1024 nt
    buffer_load_dwordx4 v[84:87], v140, s[32:35], s3 offen offset:2048 nt
    buffer_load_dwordx4 v[92:95], v140, s[32:35], s3 offen offset:3072 nt
    s_xor_b32 s3, s3, 49152
    buffer_load_dwordx4 v[96:99], v140, s[32:35], s3 offen offset:0 nt
    buffer_load_dwordx4 v[104:107], v140, s[32:35], s3 offen offset:1024 nt
    s_branch L_toC0
L_early1:
    v_mov_b32 v38, 0
L_lds55:
    ds_read_b128 v[24:27], v38 offset:56768
    s_add_u32 s81, s81, 1
    s_cmp_gt_u32 s81, 4000000
    s_cbranch_scc1 L_end
    s_waitcnt lgkmcnt(0)
    v_min3_u32 v39, v24, v25, v26
    v_min_u32 v39, v39, v27
    v_cmp_eq_u32 vcc, 0, v39
    s_cbranch_vccnz L_lds55
    v_readfirstlane_b32 s89, v27
    s_nop 0
    s_sub_u32 s89, s89, 1
    ds_read_b64_tr_b16 a[64:65], v42 offset:0
    ds_read_b64_tr_b16 a[66:67], v42 offset:1024
    ds_read_b64_tr_b16 a[68:69], v42 offset:8192
    ds_read_b64_tr_b16 a[70:71], v42 offset:9216
    s_cmp_eq_u32 s72, 0
    s_cbranch_scc0 L_cmb56
    s_sub_u32 s77, s93, s76
    s_lshl_b32 s77, s77, 2
    s_add_u32 s77, s77, s76
    v_and_b32 v4, 3, v1
    v_lshrrev_b32 v5, 2, v1
    v_lshlrev_b32 v46, 7, v5
    v_lshl_add_u32 v46, v4, 2, v46
    v_add_u32 v46, s77, v46
    v_mul_u32_u24 v4, 160, v4
    v_lshl_add_u32 v4, v5, 3, v4
    v_add_u32 v44, 56896, v4
    v_lshlrev_b32 v45, 3, v10
L_cmb56:
    s_cmp_eq_u32 s72, 1
    s_cbranch_scc0 L_gw57
    v_lshlrev_b32 v25, 7, v1
    v_lshl_add_u32 v25, v9, 24, v25
    buffer_load_dword v46, v25, s[56:59], s75 offen offset:2560 sc1
L_gw57:
    s_lshl_b32 s82, s73, 9
    s_lshl_b32 s83, s71, 2
    s_add_u32 s83, s83, 1130496
    v_lshrrev_b32 v21, 1, v1
    v_mul_u32_u24 v21, 3200, v21
L_arr58:
    buffer_load_dwordx4 v[4:7], v48, s[56:59], s82 offen sc1
    v_mov_b32 v20, s88
    s_cmp_lg_u32 s72, 0
    s_cbranch_scc1 L_arr58c
    buffer_load_dword v20, v21, s[56:59], s83 offen offset:3072 sc1
L_arr58c:
    s_add_u32 s81, s81, 1
    s_cmp_gt_u32 s81, 4000000
    s_cbranch_scc1 L_end
    s_waitcnt vmcnt(0)
    v_xor_b32 v13, s88, v4
    v_xor_b32 v15, s88, v5
    v_or_b32 v13, v13, v15
    v_xor_b32 v15, s88, v6
    v_or_b32 v13, v13, v15
    v_xor_b32 v15, s88, v7
    v_or_b32 v13, v13, v15
    v_xor_b32 v14, s88, v20
    v_and_b32 v13, 0xff, v13
    v_and_b32 v14, 0x0fffffff, v14
    v_or_b32 v13, v13, v14
    v_cmp_ne_u32 vcc, 0, v13
    s_cbranch_vccnz L_arr58
    v_and_b32 v4, 0xffffff00, v4
    v_and_b32 v5, 0xffffff00, v5
    v_and_b32 v6, 0xffffff00, v6
    v_and_b32 v7, 0xffffff00, v7
    v_permlane32_swap_b32 v4, v5
    s_nop 0
    v_permlane32_swap_b32 v6, v7
    v_add_f32 v4, v4, v5
    v_add_f32 v6, v6, v7
    s_nop 1
    v_permlane16_swap_b32 v4, v6
    v_add_f32 v4, v4, v6
    s_nop 1
    v_add_f32_dpp v4, v4, v4 row_ror:8 row_mask:0xf bank_mask:0xf
    v_mul_f32 v4, 0x3e0293ee, v4
    v_cvt_pk_bf16_f32 v4, v4, v4
    ds_write_b16 v129, v4
    v_bfe_u32 v20, v20, 28, 1
    v_cmp_ne_u32 vcc, 0, v20
    s_nop 1
    s_bcnt1_i32_b64 s78, vcc
    s_cmp_gt_u32 s78, 32
    s_cselect_b32 s78, 8193, 1
    s_and_b32 s77, s72, 3
    s_lshl_b32 s77, s77, 2
    v_mov_b32 v38, s77
    v_mov_b32 v39, s78
    ds_write_b32 v38, v39 offset:56800
L_toC0:
    v_mov_b32 v38, 0
L_lds59:
    ds_read_b128 v[24:27], v38 offset:56800
    s_add_u32 s81, s81, 1
    s_cmp_gt_u32 s81, 4000000
    s_cbranch_scc1 L_end
    s_waitcnt lgkmcnt(0)
    v_min3_u32 v39, v24, v25, v26
    v_min_u32 v39, v39, v27
    v_cmp_eq_u32 vcc, 0, v39
    s_cbranch_vccnz L_lds59
    v_readfirstlane_b32 s94, v24
    s_lshl_b32 s77, s86, 11
    s_xor_b32 s94, s94, s77
    s_and_b32 s94, s94, 8192
    ds_read_b128 v[4:7], v130
    ds_read_b128 v[8:11], v131
    ds_read_b128 v[12:15], v132
    ds_read_b128 v[16:19], v133
    ds_read_b32 v62, v61 offset:896
    s_waitcnt vmcnt(10) lgkmcnt(0)
    s_cmp_ge_u32 s72, 4
    s_cbranch_scc1 L_noclr
    s_cmp_eq_u32 s72, 1
    s_cbranch_scc0 L_c160
    v_mov_b32 v20, -1
    v_mov_b32 v21, -1
    v_mov_b32 v22, -1
    v_mov_b32 v23, -1
    s_cmp_eq_u32 s89, 0
    s_cbranch_scc1 L_sc1_61
    buffer_store_dwordx4 v[20:23], v140, s[56:59], s75 offen offset:2560
L_sc1_61r:
L_c160:
    v_min_u32 v25, 2, v1
    v_lshlrev_b32 v25, 7, v25
    s_cmp_eq_u32 s72, 2
    s_cbranch_scc0 L_c262
    s_mul_i32 s77, s71, 384
    s_add_u32 s77, s77, s76
    buffer_load_dword v46, v25, s[56:59], s77 offen sc1
L_c262:
    s_cmp_eq_u32 s72, 3
    s_cbranch_scc0 L_c363
    s_getpc_b64 s[6:7]
L_pcref2:
    s_lshl_b32 s77, s69, 8
    v_min_u32 v25, 128, v25
    v_add_u32 v25, s77, v25
    v_min_u32 v25, L_end-L_pcref2, v25
    global_load_dword v46, v25, s[6:7]
L_c363:
L_noclr:
    v_mov_b32 v20, 0
    v_mov_b32 v21, 0
    v_mov_b32 v22, 0
    v_mov_b32 v23, 0
    v_mov_b32 v24, 0
    v_mov_b32 v25, 0
    v_mov_b32 v26, 0
    v_mov_b32 v27, 0
    v_mov_b32 v28, 0
    v_mov_b32 v29, 0
    v_mov_b32 v30, 0
    v_mov_b32 v31, 0
    v_mov_b32 v32, 0
    v_mov_b32 v33, 0
    v_mov_b32 v34, 0
    v_mov_b32 v35, 0
    v_mov_b32 v36, 0
    v_mov_b32 v37, 0
    v_mov_b32 v38, 0
    v_mov_b32 v39, 0
    v_mov_b32 v40, 0
    v_mov_b32 v41, 0
    v_mov_b32 v42, 0
    v_mov_b32 v43, 0
    v_smfmac_f32_16x16x64_bf16 v[20:23], v[4:7], a[0:7], v138
    v_smfmac_f32_16x16x64_bf16 v[20:23], v[8:11], a[8:15], v138
    v_smfmac_f32_16x16x64_bf16 v[20:23], v[12:15], a[16:23], v138
    v_smfmac_f32_16x16x64_bf16 v[20:23], v[16:19], a[24:31], v138
    v_smfmac_f32_16x16x64_bf16 v[24:27], v[4:7], a[32:39], v138
    v_smfmac_f32_16x16x64_bf16 v[24:27], v[8:11], a[40:47], v138
    v_smfmac_f32_16x16x64_bf16 v[24:27], v[12:15], a[48:55], v138
    v_smfmac_f32_16x16x64_bf16 v[24:27], v[16:19], a[56:63], v138
    s_nop 3
    v_add_f32 v20, v20, v21
    v_add_f32 v22, v22, v23
    s_nop 1
    v_add_f32 v24, v24, v25
    v_add_f32 v26, v26, v27
    v_add_f32_dpp v22, v20, v22 quad_perm:[0,0,2,2] row_mask:0xf bank_mask:0xf
    s_nop 0
    v_add_f32_dpp v26, v24, v26 quad_perm:[0,0,2,2] row_mask:0xf bank_mask:0xf
    v_max_f32 v20, v22, v26
    s_nop 1
    v_max_f32_dpp v20, v20, v20 quad_perm:[2,3,0,1] row_mask:0xf bank_mask:0xf
    s_nop 1
    v_max_f32_dpp v20, v20, v20 row_ror:4 row_mask:0xf bank_mask:0xf
    s_nop 1
    v_max_f32_dpp v20, v20, v20 row_ror:8 row_mask:0xf bank_mask:0xf
    s_nop 1
    v_max_f32_dpp v20, v20, v20 row_bcast:15 row_mask:0xa bank_mask:0xf
    s_nop 1
    v_max_f32_dpp v20, v20, v20 row_bcast:31 row_mask:0xc bank_mask:0xf
    s_nop 0
    v_readlane_b32 s80, v20, 63
    s_nop 1
    v_subrev_f32 v22, s80, v22
    v_subrev_f32 v26, s80, v26
    v_exp_f32 v22, v22
    v_exp_f32 v26, v26
    s_nop 0
    v_cvt_pk_bf16_f32 v24, v22, v26
    v_add_f32 v21, v22, v26
    s_nop 0
    v_mov_b32_dpp v4, v24 row_newbcast:1 row_mask:0xf bank_mask:0xf
    v_mov_b32_dpp v5, v24 row_newbcast:3 row_mask:0xf bank_mask:0xf
    v_mov_b32_dpp v6, v24 row_newbcast:5 row_mask:0xf bank_mask:0xf
    v_mov_b32_dpp v7, v24 row_newbcast:7 row_mask:0xf bank_mask:0xf
    v_mov_b32_dpp v8, v24 row_newbcast:9 row_mask:0xf bank_mask:0xf
    v_mov_b32_dpp v9, v24 row_newbcast:11 row_mask:0xf bank_mask:0xf
    s_cmp_ge_u32 s72, 4
    s_cbranch_scc0 L_tail64
    s_waitcnt vmcnt(9)
    buffer_load_dwordx4 v[112:115], v140, s[32:35], s3 offen offset:2048 nt
    s_waitcnt vmcnt(9)
    buffer_load_dwordx4 v[120:123], v140, s[32:35], s3 offen offset:3072 nt
    s_waitcnt vmcnt(9)
    s_xor_b32 s3, s3, 16384
    buffer_load_dwordx4 v[100:103], v140, s[32:35], s3 offen offset:0 nt
    s_waitcnt vmcnt(9)
    buffer_load_dwordx4 v[108:111], v140, s[32:35], s3 offen offset:1024 nt
L_tail64:
    s_waitcnt vmcnt(10)
    v_swap_b32 v65, v72
    v_swap_b32 v66, v80
    v_swap_b32 v67, v88
    v_swap_b32 v74, v81
    v_swap_b32 v75, v89
    v_swap_b32 v83, v90
    s_cmp_ge_u32 s72, 4
    s_cbranch_scc0 L_tail65
    s_waitcnt vmcnt(9)
    buffer_load_dwordx4 v[116:119], v140, s[32:35], s3 offen offset:2048 nt
    s_waitcnt vmcnt(9)
    buffer_load_dwordx4 v[124:127], v140, s[32:35], s3 offen offset:3072 nt
    s_and_b32 s77, s72, 3
    s_lshl_b32 s77, s77, 2
    v_mov_b32 v44, s77
    v_mov_b32 v46, 1
    ds_write_b32 v44, v46 offset:56816
L_tail65:
    s_waitcnt vmcnt(8)
    v_swap_b32 v69, v76
    v_swap_b32 v70, v84
    v_swap_b32 v71, v92
    v_swap_b32 v78, v85
    v_swap_b32 v79, v93
    v_swap_b32 v87, v94
    v_smfmac_f32_16x16x64_bf16 v[28:31], v[4:7], v[64:71], v138
    v_mov_b32_dpp v10, v24 row_newbcast:13 row_mask:0xf bank_mask:0xf
    v_mov_b32_dpp v11, v24 row_newbcast:15 row_mask:0xf bank_mask:0xf
    v_smfmac_f32_16x16x64_bf16 v[32:35], v[4:7], v[72:79], v138
    v_add_f32_dpp v21, v21, v21 quad_perm:[2,3,0,1] row_mask:0xf bank_mask:0xf
    v_smfmac_f32_16x16x64_bf16 v[36:39], v[4:7], v[80:87], v138
    s_nop 0
    v_add_f32_dpp v21, v21, v21 row_ror:4 row_mask:0xf bank_mask:0xf
    v_smfmac_f32_16x16x64_bf16 v[40:43], v[4:7], v[88:95], v138
    s_nop 0
    v_add_f32_dpp v21, v21, v21 row_ror:8 row_mask:0xf bank_mask:0xf
    s_nop 1
    v_add_f32_dpp v21, v21, v21 row_bcast:15 row_mask:0xa bank_mask:0xf
    s_nop 1
    v_add_f32_dpp v21, v21, v21 row_bcast:31 row_mask:0xc bank_mask:0xf
    ds_write_b64 v142, v[20:21]
    s_cmp_ge_u32 s72, 4
    s_cbranch_scc0 L_d0y66
    s_waitcnt lgkmcnt(0)
    s_barrier
L_d0y66:
    s_waitcnt vmcnt(4)
    v_swap_b32 v97, v104
    v_swap_b32 v98, v112
    v_swap_b32 v99, v120
    v_swap_b32 v106, v113
    v_swap_b32 v107, v121
    v_swap_b32 v115, v122
    s_waitcnt vmcnt(0)
    v_swap_b32 v101, v108
    v_swap_b32 v102, v116
    v_swap_b32 v103, v124
    v_swap_b32 v110, v117
    v_swap_b32 v111, v125
    v_smfmac_f32_16x16x64_bf16 v[28:31], v[8:11], v[96:103], v138
    v_swap_b32 v119, v126
    v_smfmac_f32_16x16x64_bf16 v[32:35], v[8:11], v[104:111], v138
    s_nop 0
    v_smfmac_f32_16x16x64_bf16 v[36:39], v[8:11], v[112:119], v138
    v_smfmac_f32_16x16x64_bf16 v[40:43], v[8:11], v[120:127], v138
    s_nop 4
    ds_write2_b64 v134, v[28:29], v[32:33] offset0:0 offset1:20
    s_nop 0
    ds_write_b64 v134, v[36:37] offset:320
    ds_write_b64 v134, v[40:41] offset:480
    s_cmp_lt_u32 s72, 4
    s_cbranch_scc0 L_wo67
    s_waitcnt vmcnt(0)
    s_lshl_b32 s80, s74, 17
    s_lshl_b32 s78, s72, 15
    s_add_u32 s80, s80, s78
    s_lshl_b32 s78, s71, 7
    s_add_u32 s80, s80, s78
    s_lshl_b32 s79, s72, 12
    v_xor_b32 v12, 64, v63
    s_and_b32 s78, s72, 1
    s_lshl_b32 s78, s78, 6
    v_xor_b32 v13, s78, v63
    v_mov_b32 v38, 0
L_lds68:
    ds_read_b128 v[4:7], v38 offset:56816
    s_add_u32 s81, s81, 1
    s_cmp_gt_u32 s81, 4000000
    s_cbranch_scc1 L_end
    s_waitcnt lgkmcnt(0)
    v_min3_u32 v39, v4, v5, v6
    v_min_u32 v39, v39, v7
    v_cmp_eq_u32 vcc, 0, v39
    s_cbranch_vccnz L_lds68
    s_add_u32 m0, s79, 16384
    s_nop 0
    buffer_load_dwordx4 v63, s[40:43], s80 offen nt lds
    s_add_u32 m0, s79, 17408
    s_add_u32 s80, s80, 8192
    buffer_load_dwordx4 v12, s[40:43], s80 offen nt lds
    s_add_u32 m0, s79, 18432
    s_add_u32 s80, s80, 8192
    buffer_load_dwordx4 v63, s[40:43], s80 offen nt lds
    s_add_u32 m0, s79, 19456
    s_add_u32 s80, s80, 8192
    buffer_load_dwordx4 v12, s[40:43], s80 offen nt lds
    s_lshl_b32 s79, s72, 10
    s_add_u32 m0, s79, 45056
    s_add_u32 s78, s92, 32768
    buffer_load_dwordx4 v13, s[52:55], s92 offen nt lds
    s_add_u32 m0, s79, 49152
    s_nop 0
    buffer_load_dwordx4 v13, s[52:55], s78 offen nt lds
L_wo67:
    s_cmp_lt_u32 s72, 4
    s_cbranch_scc1 L_comb69
    s_waitcnt vmcnt(0) lgkmcnt(0)
L_comb69d:
    s_barrier
    s_branch L_ocomb70
L_comb69:
    s_cmp_lg_u32 s72, 0
    s_waitcnt lgkmcnt(0)
    v_add_u32 v33, 2432, v44
    s_barrier
    s_cbranch_scc1 L_comb69d
    ds_read_b64 v[20:21], v45 offset:61760
    ds_read2_b64 v[4:7], v44 offset0:0 offset1:76
    ds_read2_b64 v[8:11], v44 offset0:152 offset1:228
    s_waitcnt lgkmcnt(2)
    v_max_f32_dpp v22, v20, v20 quad_perm:[1,0,3,2] row_mask:0xf bank_mask:0xf
    s_nop 1
    v_max_f32_dpp v22, v22, v22 quad_perm:[2,3,0,1] row_mask:0xf bank_mask:0xf
    s_nop 1
    v_max_f32_dpp v22, v22, v22 row_half_mirror row_mask:0xf bank_mask:0xf
    v_sub_f32 v23, v20, v22
    v_exp_f32 v23, v23
    s_nop 0
    v_mul_f32 v24, v23, v21
    s_waitcnt lgkmcnt(0)
    v_mul_f32_dpp v26, v23, v4 row_newbcast:0 row_mask:0xf bank_mask:0xf
    v_mul_f32_dpp v27, v23, v5 row_newbcast:0 row_mask:0xf bank_mask:0xf
    v_add_f32_dpp v24, v24, v24 quad_perm:[1,0,3,2] row_mask:0xf bank_mask:0xf
    v_fmac_f32_dpp v26, v23, v6 row_newbcast:1 row_mask:0xf bank_mask:0xf
    v_fmac_f32_dpp v27, v23, v7 row_newbcast:1 row_mask:0xf bank_mask:0xf
    v_add_f32_dpp v24, v24, v24 quad_perm:[2,3,0,1] row_mask:0xf bank_mask:0xf
    v_fmac_f32_dpp v26, v23, v8 row_newbcast:2 row_mask:0xf bank_mask:0xf
    v_fmac_f32_dpp v27, v23, v9 row_newbcast:2 row_mask:0xf bank_mask:0xf
    v_add_f32_dpp v24, v24, v24 row_half_mirror row_mask:0xf bank_mask:0xf
    v_fmac_f32_dpp v26, v23, v10 row_newbcast:3 row_mask:0xf bank_mask:0xf
    v_fmac_f32_dpp v27, v23, v11 row_newbcast:3 row_mask:0xf bank_mask:0xf
    v_rcp_f32 v25, v24
    v_log_f32 v24, v24
    s_nop 0
    v_add_f32 v22, v22, v24
    s_barrier
    ds_read2_b64 v[12:15], v33 offset0:0 offset1:76
    ds_read2_b64 v[16:19], v33 offset0:152 offset1:228
    s_waitcnt lgkmcnt(1)
    v_fmac_f32_dpp v26, v23, v12 row_newbcast:4 row_mask:0xf bank_mask:0xf
    v_fmac_f32_dpp v27, v23, v13 row_newbcast:4 row_mask:0xf bank_mask:0xf
    s_nop 0
    v_fmac_f32_dpp v26, v23, v14 row_newbcast:5 row_mask:0xf bank_mask:0xf
    v_fmac_f32_dpp v27, v23, v15 row_newbcast:5 row_mask:0xf bank_mask:0xf
    s_waitcnt lgkmcnt(0)
    v_fmac_f32_dpp v26, v23, v16 row_newbcast:6 row_mask:0xf bank_mask:0xf
    v_fmac_f32_dpp v27, v23, v17 row_newbcast:6 row_mask:0xf bank_mask:0xf
    s_cmp_eq_u32 s89, 0
    s_cbranch_scc1 L_sc1_71
    v_fmac_f32_dpp v26, v23, v18 row_newbcast:7 row_mask:0xf bank_mask:0xf
    v_fmac_f32_dpp v27, v23, v19 row_newbcast:7 row_mask:0xf bank_mask:0xf
    v_mul_f32 v26, v26, v25
    v_mul_f32 v27, v27, v25
    v_cvt_pk_bf16_f32 v26, v26, v27
    buffer_store_dword v26, v46, s[56:59], 0 offen
    buffer_store_dword v22, v141, s[56:59], s93 offen offset:2048
L_sc1_71r:
L_ocomb70:
    v_cmp_gt_u32 vcc, 8, v2
    s_nop 1
    v_cndmask_b32 v62, 0, v62, vcc
    v_and_b32 v63, 0xffff0000, v62
    v_lshlrev_b32 v62, 16, v62
    s_cmp_eq_u32 s72, 3
    s_cbranch_scc0 L_z0c72
    v_mov_b32 v16, -1
    v_mov_b32 v17, -1
    v_mov_b32 v18, -1
    v_mov_b32 v19, -1
    s_add_u32 s77, s90, 278528
    buffer_store_dwordx4 v[16:19], v45, s[56:59], s77 offen sc1
L_z0c72:
L_d2:
    s_barrier
    s_cmp_lt_u32 s72, 4
    s_cbranch_scc0 L_wos73
    s_mov_b32 s83, 16384
    buffer_load_dword v12, v51, s[56:59], 0 offen offset:2048 sc1
    buffer_load_dwordx4 v[4:7], v50, s[56:59], 0 offen sc1
    buffer_load_dwordx4 v[8:11], v50, s[56:59], 0 offen offset:1024 sc1
    s_waitcnt vmcnt(3)
    s_barrier
    ds_read_b64_tr_b16 a[72:73], v139 offset:16384
    ds_read_b64_tr_b16 a[74:75], v139 offset:16896
    ds_read_b64_tr_b16 a[76:77], v139 offset:20480
    ds_read_b64_tr_b16 a[78:79], v139 offset:20992
    ds_read_b64_tr_b16 a[80:81], v139 offset:24576
    ds_read_b64_tr_b16 a[82:83], v139 offset:25088
    ds_read_b64_tr_b16 a[84:85], v139 offset:28672
    ds_read_b64_tr_b16 a[86:87], v139 offset:29184
    s_branch L_poll74c
L_poll74:
    buffer_load_dword v12, v51, s[56:59], 0 offen offset:2048 sc1
    buffer_load_dwordx4 v[4:7], v50, s[56:59], 0 offen sc1
    buffer_load_dwordx4 v[8:11], v50, s[56:59], 0 offen offset:1024 sc1
    s_add_u32 s81, s81, 1
    s_cmp_gt_u32 s81, 4000000
    s_cbranch_scc1 L_end
L_poll74c:
    s_waitcnt vmcnt(1) lgkmcnt(0)
    v_mfma_f32_16x16x32_bf16 v[20:23], a[76:79], v[4:7], 0
    v_sub_f32_dpp v13, v12, v12 quad_perm:[1,0,3,2] row_mask:0xf bank_mask:0xf
    v_mfma_f32_16x16x32_bf16 v[16:19], a[72:75], v[4:7], 0
    v_exp_f32 v13, v13
    s_waitcnt vmcnt(0)
    v_mfma_f32_16x16x32_bf16 v[20:23], a[84:87], v[8:11], v[20:23]
    v_add_f32 v13, 1.0, v13
    v_mfma_f32_16x16x32_bf16 v[16:19], a[80:83], v[8:11], v[16:19]
    v_rcp_f32 v13, v13
    v_max3_u32 v47, v4, v5, v6
    v_max3_u32 v47, v47, v7, v8
    v_max3_u32 v47, v47, v9, v10
    v_max3_u32 v47, v47, v11, v12
    v_cmp_eq_u32 vcc, -1, v47
    s_cbranch_vccnz L_poll74
    s_nop 0
    v_add_f32_dpp v16, v20, v16 row_ror:8 row_mask:0xf bank_mask:0xf
    v_add_f32_dpp v17, v21, v17 row_ror:8 row_mask:0xf bank_mask:0xf
    v_add_f32_dpp v18, v22, v18 row_ror:8 row_mask:0xf bank_mask:0xf
    v_add_f32_dpp v19, v23, v19 row_ror:8 row_mask:0xf bank_mask:0xf
    v_mul_f32 v16, v16, v13
    v_mul_f32 v17, v17, v13
    v_mul_f32 v18, v18, v13
    v_mul_f32 v19, v19, v13
    v_add_f32_dpp v16, v16, v16 quad_perm:[1,0,3,2] row_mask:0xf bank_mask:0xf
    v_add_f32_dpp v17, v17, v17 quad_perm:[1,0,3,2] row_mask:0xf bank_mask:0xf
    v_add_f32_dpp v18, v18, v18 quad_perm:[1,0,3,2] row_mask:0xf bank_mask:0xf
    v_add_f32_dpp v19, v19, v19 quad_perm:[1,0,3,2] row_mask:0xf bank_mask:0xf
    v_cvt_pk_bf16_f32 v16, v16, v17
    v_cvt_pk_bf16_f32 v17, v18, v19
    buffer_store_dwordx2 v[16:17], v59, s[56:59], s83 offen sc1
    s_barrier
    buffer_load_dwordx4 v[24:27], v48, s[56:59], 0 offen offset:2048 sc1
    ds_read_b64_tr_b16 a[96:97], v139 offset:45056
    ds_read_b64_tr_b16 a[98:99], v139 offset:45568
    ds_read_b64_tr_b16 a[100:101], v139 offset:49152
    ds_read_b64_tr_b16 a[102:103], v139 offset:49664
    s_branch L_gub75
L_wos73:
    s_barrier
    s_and_b32 s79, s72, 3
    s_lshl_b32 s79, s79, 10
    s_add_u32 m0, s79, 32768
    s_add_u32 s78, s91, 88064
    v_mov_b32 v12, -1
    v_mov_b32 v13, -1
    v_mov_b32 v14, -1
    v_mov_b32 v15, -1
    s_cmp_eq_u32 s72, 7
    s_barrier
    s_cbranch_scc1 L_gub75c
    buffer_load_dwordx4 v49, s[44:47], s91 offen lds
    s_add_u32 m0, s79, 38912
    s_nop 0
    buffer_load_dwordx4 v49, s[48:51], s91 offen lds
    s_add_u32 m0, s79, 35840
    s_nop 0
    buffer_load_dwordx4 v49, s[44:47], s78 offen lds
    s_add_u32 m0, s79, 41984
    s_nop 0
    buffer_load_dwordx4 v49, s[48:51], s78 offen lds
    s_waitcnt vmcnt(2)
    s_branch L_gub75
L_gub75c:
    s_cmp_eq_u32 s89, 0
    s_cbranch_scc1 L_sc1_76
    buffer_store_dwordx4 v[12:15], v140, s[56:59], s75 offen offset:0
    buffer_store_dwordx4 v[12:15], v140, s[56:59], s75 offen offset:1024
L_sc1_76r:
    s_add_u32 s77, s90, 540672
    buffer_store_dwordx4 v[12:15], v45, s[56:59], s77 offen sc1
L_gub75:
    s_barrier
    v_lshrrev_b32 v20, 2, v2
    v_lshl_add_u32 v20, v3, 3, v20
    v_mul_u32_u24 v20, 96, v20
    v_and_b32 v21, 24, v139
    s_lshr_b32 s77, s72, 1
    s_lshl_b32 s77, s77, 5
    s_and_b32 s78, s72, 1
    s_mul_i32 s78, s78, 6144
    s_add_u32 s77, s77, s78
    v_add3_u32 v20, v20, v21, s77
    ds_read_b64_tr_b16 a[88:89], v20 offset:32768
    ds_read_b64_tr_b16 a[90:91], v20 offset:33152
    s_cmp_lt_u32 s72, 4
    s_cbranch_scc1 L_xi77
    s_add_u32 s82, s94, 16384
L_xp79:
    buffer_load_dwordx4 v[4:7], v52, s[56:59], s82 offen offset:0 sc1
    buffer_load_dwordx4 v[8:11], v52, s[56:59], s82 offen offset:1024 sc1
    buffer_load_dwordx4 v[12:15], v52, s[56:59], s82 offen offset:2048 sc1
    buffer_load_dwordx4 v[16:19], v52, s[56:59], s82 offen offset:3072 sc1
    s_add_u32 s81, s81, 1
    s_cmp_gt_u32 s81, 4000000
    s_cbranch_scc1 L_end
    s_waitcnt vmcnt(3)
    v_mfma_f32_16x16x32_bf16 v[28:31], a[108:111], v[4:7], v[62:65]
    v_max3_u32 v4, v4, v5, v6
    v_max_u32 v4, v4, v7
    s_waitcnt vmcnt(2)
    v_mfma_f32_16x16x32_bf16 v[28:31], a[108:111], v[8:11], v[28:31]
    v_max3_u32 v4, v4, v8, v9
    v_max3_u32 v4, v4, v10, v11
    s_waitcnt vmcnt(1)
    v_mfma_f32_16x16x32_bf16 v[28:31], a[108:111], v[12:15], v[28:31]
    v_max3_u32 v4, v4, v12, v13
    v_max3_u32 v4, v4, v14, v15
    s_waitcnt vmcnt(0)
    v_mfma_f32_16x16x32_bf16 v[28:31], a[108:111], v[16:19], v[28:31]
    v_max3_u32 v4, v4, v16, v17
    v_max3_u32 v4, v4, v18, v19
    v_cmp_eq_u32 vcc, -1, v4
    s_cbranch_vccnz L_xp79
    s_nop 3
    v_add_f32_dpp v28, v28, v28 row_ror:8 row_mask:0xf bank_mask:0xf
    v_add_f32_dpp v29, v29, v29 row_ror:8 row_mask:0xf bank_mask:0xf
    v_cvt_pk_bf16_f32 v4, v28, v29
    ds_write_b32 v61, v4
    v_lshlrev_b32 v6, 16, v4
    v_and_b32 v7, 0xffff0000, v4
    s_nop 0
    v_mov_b32_dpp v62, v6 quad_perm:[0,1,2,3] row_mask:0xf bank_mask:0x3
    v_mov_b32_dpp v63, v7 quad_perm:[0,1,2,3] row_mask:0xf bank_mask:0x3
    s_branch L_xs78
L_xi77:
    v_accvgpr_read_b32 v28, a104
    v_accvgpr_read_b32 v32, a104
    v_accvgpr_read_b32 v29, a105
    v_accvgpr_read_b32 v33, a105
    v_accvgpr_read_b32 v30, a106
    v_accvgpr_read_b32 v34, a106
    v_accvgpr_read_b32 v31, a107
    v_accvgpr_read_b32 v35, a107
    v_mov_b32 v37, 0
    v_mov_b32 v38, 0x3727c5ac
    v_mov_b32 v39, 0xc0135761
    s_lshl_b32 s82, s72, 7
    s_mov_b32 s83, 278528
    v_mov_b32_dpp v28, v37 quad_perm:[0,1,2,3] row_mask:0xf bank_mask:0xc
    v_mov_b32_dpp v29, v37 quad_perm:[0,1,2,3] row_mask:0xf bank_mask:0xc
    v_mov_b32_dpp v30, v37 quad_perm:[0,1,2,3] row_mask:0xf bank_mask:0xc
    v_mov_b32_dpp v31, v37 quad_perm:[0,1,2,3] row_mask:0xf bank_mask:0xc
    v_mov_b32_dpp v32, v37 quad_perm:[0,1,2,3] row_mask:0xf bank_mask:0x3
    v_mov_b32_dpp v33, v37 quad_perm:[0,1,2,3] row_mask:0xf bank_mask:0x3
    v_mov_b32_dpp v34, v37 quad_perm:[0,1,2,3] row_mask:0xf bank_mask:0x3
    v_mov_b32_dpp v35, v37 quad_perm:[0,1,2,3] row_mask:0xf bank_mask:0x3
    s_waitcnt vmcnt(0)
    v_and_b32 v24, 0xffffff00, v24
    v_and_b32 v25, 0xffffff00, v25
    v_and_b32 v26, 0xffffff00, v26
    v_and_b32 v27, 0xffffff00, v27
    v_permlane32_swap_b32 v24, v25
    s_nop 0
    v_permlane32_swap_b32 v26, v27
    v_add_f32 v24, v24, v25
    v_add_f32 v26, v26, v27
    s_nop 1
    v_permlane16_swap_b32 v24, v26
    v_add_f32 v24, v24, v26
    s_nop 1
    v_add_f32_dpp v24, v24, v24 row_ror:8 row_mask:0xf bank_mask:0xf
    v_mov_b32 v137, v24
L_xs78:
    s_waitcnt lgkmcnt(0)
    s_barrier
    ds_read_b128 v[4:7], v128
    ds_read_b128 v[8:11], v128 offset:64
    s_cmp_ge_u32 s72, 6
    s_cbranch_scc1 L_gu680
    ds_read_b64_tr_b16 a[92:93], v20 offset:35840
    ds_read_b64_tr_b16 a[94:95], v20 offset:36224
    s_waitcnt lgkmcnt(3)
    v_mfma_f32_16x16x32_bf16 v[12:15], a[88:91], v[4:7], 0
    s_waitcnt lgkmcnt(0)
    v_mfma_f32_16x16x32_bf16 v[12:15], a[92:95], v[8:11], v[12:15]
    s_cmp_eq_u32 s89, 0
    s_cbranch_scc1 L_sc1_82
    s_nop 5
    v_cvt_pk_bf16_f32 v12, v12, v13
    v_cvt_pk_bf16_f32 v13, v14, v15
    buffer_store_dwordx2 v[12:13], v57, s[56:59], 0 offen
L_sc1_82r:
    s_cmp_ge_u32 s72, 3
    s_cbranch_scc1 L_gud81
    s_waitcnt vmcnt(0)
L_poll83:
    buffer_load_dwordx2 v[16:17], v55, s[56:59], 0 offen offset:2176 sc1
    buffer_load_dwordx4 v[8:11], v48, s[56:59], s82 offen offset:2560 sc1
    buffer_load_dwordx4 v[12:15], v48, s[56:59], s82 offen offset:2688 sc1
    buffer_load_dwordx4 v[20:23], v54, s[56:59], 0 offen offset:3328 sc1
    s_add_u32 s81, s81, 1
    s_cmp_gt_u32 s81, 4000000
    s_cbranch_scc1 L_end
    s_waitcnt vmcnt(3)
    v_add_f32_dpp v36, v16, v16 quad_perm:[1,0,3,2] row_mask:0xf bank_mask:0xf
    v_add_f32_dpp v37, v17, v17 quad_perm:[1,0,3,2] row_mask:0xf bank_mask:0xf
    s_waitcnt vmcnt(2)
    v_mfma_f32_16x16x32_bf16 v[4:7], v[8:11], v[28:31], 0
    v_add_f32_dpp v36, v36, v36 quad_perm:[2,3,0,1] row_mask:0xf bank_mask:0xf
    v_add_f32_dpp v37, v37, v37 quad_perm:[2,3,0,1] row_mask:0xf bank_mask:0xf
    s_waitcnt vmcnt(1)
    v_mfma_f32_16x16x32_bf16 v[4:7], v[12:15], v[32:35], v[4:7]
    s_waitcnt vmcnt(0)
    v_mfma_f32_16x16x32_bf16 v[24:27], v[20:23], a[104:107], 0
    v_max3_u32 v47, v8, v9, v10
    v_max3_u32 v47, v47, v11, v12
    v_max3_u32 v47, v47, v13, v14
    v_max3_u32 v47, v47, v15, v16
    v_max3_u32 v47, v47, v17, v20
    v_max3_u32 v47, v47, v21, v22
    v_max_u32 v47, v47, v23
    v_cmp_eq_u32 vcc, -1, v47
    s_cbranch_vccnz L_poll83
    v_add_f32_dpp v36, v36, v36 row_half_mirror row_mask:0xf bank_mask:0xf
    v_add_f32_dpp v37, v37, v37 row_half_mirror row_mask:0xf bank_mask:0xf
    v_mov_b32_dpp v24, v26 quad_perm:[0,1,2,3] row_mask:0xf bank_mask:0xc
    v_mov_b32_dpp v25, v26 quad_perm:[0,1,2,3] row_mask:0xf bank_mask:0xc
    v_permlane32_swap_b32 v4, v5
    v_permlane32_swap_b32 v6, v7
    v_permlane32_swap_b32 v24, v25
    v_add_f32 v53, v24, v25
    v_add_f32 v58, v24, v25
    v_add_f32 v4, v4, v5
    v_add_f32 v8, v6, v7
    v_fmamk_f32 v36, v36, 0x3b000000, v38
    v_fma_f32 v36, -v37, v37, v36
    v_permlane16_swap_b32 v4, v8
    v_max_f32 v36, v36, v38
    v_rsq_f32 v36, v36
    v_permlane16_swap_b32 v53, v58
    v_fma_f32 v4, -v37, v53, v4
    v_mul_f32 v4, v4, v36
    v_mul_f32 v5, v4, v4
    v_fmac_f32 v39, 0xbdd2d3e8, v5
    v_mul_f32 v6, v39, v4
    v_exp_f32 v6, v6
    v_fma_f32 v8, -v37, v58, v8
    v_add_f32 v6, 1.0, v6
    v_rcp_f32 v6, v6
    v_mul_f32 v8, v8, v36
    v_mul_f32 v4, v4, v6
    v_mul_f32 v8, v8, v4
    v_cvt_pk_bf16_f32 v8, v8, v8
    ds_write_b16 v135, v8
    s_branch L_gud81
L_gu680:
    s_cmp_lg_u32 s72, 7
    s_cbranch_scc1 L_gud81
    s_waitcnt lgkmcnt(1)
    v_mfma_f32_16x16x32_bf16 v[16:19], v[4:7], v[4:7], 0
    s_waitcnt lgkmcnt(0)
    v_mfma_f32_16x16x32_bf16 v[16:19], v[8:11], v[8:11], v[16:19]
    s_cmp_eq_u32 s89, 0
    s_cbranch_scc1 L_sc1_84
    s_nop 5
    v_cndmask_b32 v16, v16, v17, s[12:13]
    v_cndmask_b32 v18, v18, v19, s[16:17]
    v_cndmask_b32 v16, v16, v18, s[14:15]
    buffer_store_dword v16, v53, s[56:59], 0 offen offset:2176
L_sc1_84r:
L_gud81:
    s_waitcnt lgkmcnt(0)
    s_barrier
    s_cmp_lt_u32 s72, 4
    s_cbranch_scc0 L_dn85
    ds_read_b128 v[4:7], v136
    ds_read_b128 v[8:11], v136 offset:64
    s_waitcnt lgkmcnt(1)
    v_mfma_f32_16x16x32_bf16 v[12:15], a[96:99], v[4:7], 0
    s_waitcnt lgkmcnt(0)
    v_mfma_f32_16x16x32_bf16 v[12:15], a[100:103], v[8:11], v[12:15]
    s_nop 7
    v_cvt_pk_bf16_f32 v12, v12, v13
    v_cvt_pk_bf16_f32 v13, v14, v15
    buffer_store_dwordx2 v[12:13], v60, s[56:59], s83 offen sc1
L_dn85:
    v_mov_b32 v20, 0
    v_mov_b32 v21, 0
    v_mov_b32 v22, 0
    v_mov_b32 v23, 0
    v_mov_b32 v24, 0
    v_mov_b32 v25, 0
    v_mov_b32 v26, 0
    v_mov_b32 v27, 0
    v_mov_b32 v28, 0
    v_mov_b32 v29, 0
    v_mov_b32 v30, 0
    v_mov_b32 v31, 0
    v_mov_b32 v32, 0
    v_mov_b32 v33, 0
    v_mov_b32 v34, 0
    v_mov_b32 v35, 0
    v_mov_b32 v36, 0
    v_mov_b32 v37, 0
    v_mov_b32 v38, 0
    v_mov_b32 v39, 0
    v_mov_b32 v40, 0
    v_mov_b32 v41, 0
    v_mov_b32 v42, 0
    v_mov_b32 v43, 0
    s_barrier
    s_cmp_lt_u32 s72, 4
    s_cbranch_scc1 L_xi86
    s_add_u32 s82, s94, 278528
    s_sleep 9
L_xp88:
    buffer_load_dwordx4 v[4:7], v52, s[56:59], s82 offen offset:0 sc1
    buffer_load_dwordx4 v[8:11], v52, s[56:59], s82 offen offset:1024 sc1
    buffer_load_dwordx4 v[12:15], v52, s[56:59], s82 offen offset:2048 sc1
    buffer_load_dwordx4 v[16:19], v52, s[56:59], s82 offen offset:3072 sc1
    s_add_u32 s81, s81, 1
    s_cmp_gt_u32 s81, 4000000
    s_cbranch_scc1 L_end
    s_waitcnt vmcnt(3)
    v_mfma_f32_16x16x32_bf16 v[44:47], a[108:111], v[4:7], v[62:65]
    v_max3_u32 v4, v4, v5, v6
    v_max_u32 v4, v4, v7
    s_waitcnt vmcnt(2)
    v_mfma_f32_16x16x32_bf16 v[44:47], a[108:111], v[8:11], v[44:47]
    v_max3_u32 v4, v4, v8, v9
    v_max3_u32 v4, v4, v10, v11
    s_waitcnt vmcnt(1)
    v_mfma_f32_16x16x32_bf16 v[44:47], a[108:111], v[12:15], v[44:47]
    v_max3_u32 v4, v4, v12, v13
    v_max3_u32 v4, v4, v14, v15
    s_waitcnt vmcnt(0)
    v_mfma_f32_16x16x32_bf16 v[44:47], a[108:111], v[16:19], v[44:47]
    v_max3_u32 v4, v4, v16, v17
    v_max3_u32 v4, v4, v18, v19
    v_cmp_eq_u32 vcc, -1, v4
    s_cbranch_vccnz L_xp88
    s_nop 3
    v_add_f32_dpp v44, v44, v44 row_ror:8 row_mask:0xf bank_mask:0xf
    v_add_f32_dpp v45, v45, v45 row_ror:8 row_mask:0xf bank_mask:0xf
    v_cvt_pk_bf16_f32 v4, v44, v45
    ds_write_b32 v61, v4
    v_lshlrev_b32 v6, 16, v4
    v_and_b32 v7, 0xffff0000, v4
    s_nop 0
    v_mov_b32_dpp v62, v6 quad_perm:[0,1,2,3] row_mask:0xf bank_mask:0x3
    v_mov_b32_dpp v63, v7 quad_perm:[0,1,2,3] row_mask:0xf bank_mask:0x3
    s_branch L_xs87
L_xi86:
    v_mov_b32 v12, -1
    v_mov_b32 v13, -1
    v_mov_b32 v14, -1
    v_mov_b32 v15, -1
    s_cmp_eq_u32 s72, 1
    s_cbranch_scc0 L_oclr89
    s_lshl_b32 s77, s71, 8
    s_add_u32 s77, s77, s76
    v_lshl_add_u32 v16, v3, 28, v140
    s_cmp_eq_u32 s89, 0
    s_cbranch_scc1 L_sc1_90
    buffer_store_dwordx4 v[12:15], v16, s[56:59], s77 offen
    buffer_store_dword v12, v141, s[56:59], s93 offen offset:2048
L_sc1_90r:
L_oclr89:
    s_cmp_eq_u32 s72, 2
    s_cbranch_scc0 L_zclr91
    s_add_u32 s77, s90, 802816
    buffer_store_dwordx4 v[12:15], v45, s[56:59], s77 offen sc1
L_zclr91:
    s_waitcnt vmcnt(0)
L_xs87:
    s_waitcnt lgkmcnt(0)
    s_barrier
    ds_read_b128 v[4:7], v128
    ds_read_b128 v[8:11], v128 offset:64
    s_cmp_eq_u32 s72, 7
    s_cbranch_scc1 L_q792
    s_waitcnt lgkmcnt(1)
    v_mfma_f32_16x16x32_bf16 v[12:15], a[64:67], v[4:7], 0
    s_waitcnt lgkmcnt(0)
    v_mfma_f32_16x16x32_bf16 v[12:15], a[68:71], v[8:11], v[12:15]
    s_cmp_eq_u32 s89, 0
    s_cbranch_scc1 L_sc1_94
    s_nop 5
    buffer_store_dwordx4 v[12:15], v56, s[56:59], 0 offen
L_sc1_94r:
    s_branch L_qe93
L_q792:
    s_waitcnt lgkmcnt(1)
    v_mfma_f32_16x16x32_bf16 v[16:19], v[4:7], v[4:7], 0
    v_mfma_f32_16x16x32_bf16 v[12:15], a[64:67], v[4:7], 0
    s_waitcnt lgkmcnt(0)
    v_mfma_f32_16x16x32_bf16 v[16:19], v[8:11], v[8:11], v[16:19]
    v_mfma_f32_16x16x32_bf16 v[12:15], a[68:71], v[8:11], v[12:15]
    s_cmp_eq_u32 s89, 0
    s_cbranch_scc1 L_sc1_95
    s_nop 4
    v_cndmask_b32 v16, v16, v17, s[12:13]
    v_cndmask_b32 v18, v18, v19, s[16:17]
    v_cndmask_b32 v16, v16, v18, s[14:15]
    buffer_store_dwordx4 v[12:15], v56, s[56:59], 0 offen
    buffer_store_dword v16, v53, s[56:59], 0 offen offset:2432
L_sc1_95r:
L_qe93:
    s_cmp_ge_u32 s72, 4
    s_cbranch_scc1 L_hiC1
    s_lshl_b32 s82, s73, 9
    v_mov_b32 v16, 0x3727c5ac
    s_waitcnt vmcnt(0)
L_poll96:
    buffer_load_dwordx2 v[8:9], v49, s[56:59], 0 offen offset:2432 sc1
    buffer_load_dwordx4 v[4:7], v48, s[56:59], s82 offen sc1
    s_add_u32 s81, s81, 1
    s_cmp_gt_u32 s81, 4000000
    s_cbranch_scc1 L_end
    s_waitcnt vmcnt(1)
    v_add_f32_dpp v10, v8, v8 quad_perm:[1,0,3,2] row_mask:0xf bank_mask:0xf
    v_add_f32_dpp v11, v9, v9 quad_perm:[1,0,3,2] row_mask:0xf bank_mask:0xf
    s_waitcnt vmcnt(0)
    v_max3_u32 v47, v4, v5, v6
    v_max3_u32 v47, v47, v7, v8
    v_max_u32 v47, v47, v9
    v_cmp_eq_u32 vcc, -1, v47
    s_cbranch_vccnz L_poll96
    v_add_f32_dpp v10, v10, v10 quad_perm:[2,3,0,1] row_mask:0xf bank_mask:0xf
    v_add_f32_dpp v11, v11, v11 quad_perm:[2,3,0,1] row_mask:0xf bank_mask:0xf
    v_permlane32_swap_b32 v4, v5
    v_add_f32_dpp v10, v10, v10 row_half_mirror row_mask:0xf bank_mask:0xf
    v_add_f32_dpp v11, v11, v11 row_half_mirror row_mask:0xf bank_mask:0xf
    v_permlane32_swap_b32 v6, v7
    v_add_f32 v4, v4, v5
    v_add_f32 v6, v6, v7
    v_fmamk_f32 v10, v10, 0x3b000000, v16
    v_fma_f32 v10, -v11, v11, v10
    v_permlane16_swap_b32 v4, v6
    v_add_f32 v4, v4, v6
    v_max_f32 v10, v10, v16
    v_rsq_f32 v10, v10
    v_add_f32_dpp v4, v4, v4 row_ror:8 row_mask:0xf bank_mask:0xf
    v_mul_f32 v10, 0x3e0293ee, v10
    v_fma_f32 v4, -v11, v137, v4
    v_mul_f32 v4, v4, v10
    v_cvt_pk_bf16_f32 v4, v4, v4
    ds_write_b16 v129, v4
    s_branch L_toC1
L_hiC1:
    v_mov_b32 v44, -1
    v_mov_b32 v45, -1
    v_mov_b32 v46, -1
    v_mov_b32 v47, -1
L_toC1:
    s_waitcnt lgkmcnt(0)
    s_barrier
    ds_read_b128 v[4:7], v130
    ds_read_b128 v[8:11], v131
    ds_read_b128 v[12:15], v132
    ds_read_b128 v[16:19], v133
    s_cmp_eq_u32 s72, 4
    s_cbranch_scc0 L_gclr97
    s_cmp_eq_u32 s89, 0
    s_cbranch_scc1 L_sc1_98
    buffer_store_dwordx4 v[44:47], v140, s[56:59], s75 offen offset:2560
L_sc1_98r:
L_gclr97:
    s_waitcnt lgkmcnt(3)
    v_smfmac_f32_16x16x64_bf16 v[20:23], v[4:7], a[0:7], v138
    s_waitcnt lgkmcnt(2)
    v_smfmac_f32_16x16x64_bf16 v[20:23], v[8:11], a[8:15], v138
    s_waitcnt lgkmcnt(1)
    v_smfmac_f32_16x16x64_bf16 v[20:23], v[12:15], a[16:23], v138
    s_waitcnt lgkmcnt(0)
    v_smfmac_f32_16x16x64_bf16 v[20:23], v[16:19], a[24:31], v138
    v_smfmac_f32_16x16x64_bf16 v[24:27], v[4:7], a[32:39], v138
    v_smfmac_f32_16x16x64_bf16 v[24:27], v[8:11], a[40:47], v138
    v_smfmac_f32_16x16x64_bf16 v[24:27], v[12:15], a[48:55], v138
    v_smfmac_f32_16x16x64_bf16 v[24:27], v[16:19], a[56:63], v138
    s_nop 3
    v_add_f32 v20, v20, v21
    v_add_f32 v22, v22, v23
    s_nop 1
    v_add_f32 v24, v24, v25
    v_add_f32 v26, v26, v27
    v_add_f32_dpp v22, v20, v22 quad_perm:[0,0,2,2] row_mask:0xf bank_mask:0xf
    s_nop 0
    v_add_f32_dpp v26, v24, v26 quad_perm:[0,0,2,2] row_mask:0xf bank_mask:0xf
    v_max_f32 v20, v22, v26
    s_nop 1
    v_max_f32_dpp v20, v20, v20 quad_perm:[2,3,0,1] row_mask:0xf bank_mask:0xf
    s_nop 1
    v_max_f32_dpp v20, v20, v20 row_ror:4 row_mask:0xf bank_mask:0xf
    s_nop 1
    v_max_f32_dpp v20, v20, v20 row_ror:8 row_mask:0xf bank_mask:0xf
    s_nop 1
    v_max_f32_dpp v20, v20, v20 row_bcast:15 row_mask:0xa bank_mask:0xf
    s_nop 1
    v_max_f32_dpp v20, v20, v20 row_bcast:31 row_mask:0xc bank_mask:0xf
    s_nop 0
    v_readlane_b32 s80, v20, 63
    s_nop 1
    v_subrev_f32 v22, s80, v22
    v_subrev_f32 v26, s80, v26
    v_exp_f32 v22, v22
    v_exp_f32 v26, v26
    s_nop 0
    v_cvt_pk_bf16_f32 v24, v22, v26
    v_add_f32 v21, v22, v26
    s_nop 0
    v_mov_b32_dpp v4, v24 row_newbcast:1 row_mask:0xf bank_mask:0xf
    v_mov_b32_dpp v5, v24 row_newbcast:3 row_mask:0xf bank_mask:0xf
    v_mov_b32_dpp v6, v24 row_newbcast:5 row_mask:0xf bank_mask:0xf
    v_mov_b32_dpp v7, v24 row_newbcast:7 row_mask:0xf bank_mask:0xf
    v_mov_b32_dpp v8, v24 row_newbcast:9 row_mask:0xf bank_mask:0xf
    v_mov_b32_dpp v9, v24 row_newbcast:11 row_mask:0xf bank_mask:0xf
    v_smfmac_f32_16x16x64_bf16 v[28:31], v[4:7], v[64:71], v138
    v_mov_b32_dpp v10, v24 row_newbcast:13 row_mask:0xf bank_mask:0xf
    v_mov_b32_dpp v11, v24 row_newbcast:15 row_mask:0xf bank_mask:0xf
    v_smfmac_f32_16x16x64_bf16 v[32:35], v[4:7], v[72:79], v138
    v_add_f32_dpp v21, v21, v21 quad_perm:[2,3,0,1] row_mask:0xf bank_mask:0xf
    v_smfmac_f32_16x16x64_bf16 v[28:31], v[8:11], v[96:103], v138
    s_nop 0
    v_add_f32_dpp v21, v21, v21 row_ror:4 row_mask:0xf bank_mask:0xf
    v_smfmac_f32_16x16x64_bf16 v[32:35], v[8:11], v[104:111], v138
    s_nop 0
    v_add_f32_dpp v21, v21, v21 row_ror:8 row_mask:0xf bank_mask:0xf
    v_smfmac_f32_16x16x64_bf16 v[36:39], v[4:7], v[80:87], v138
    s_nop 0
    v_add_f32_dpp v21, v21, v21 row_bcast:15 row_mask:0xa bank_mask:0xf
    v_smfmac_f32_16x16x64_bf16 v[36:39], v[8:11], v[112:119], v138
    s_nop 0
    v_add_f32_dpp v21, v21, v21 row_bcast:31 row_mask:0xc bank_mask:0xf
    ds_write_b64 v142, v[20:21]
    v_smfmac_f32_16x16x64_bf16 v[40:43], v[4:7], v[88:95], v138
    ds_write2_b64 v134, v[28:29], v[32:33] offset0:0 offset1:20
    v_smfmac_f32_16x16x64_bf16 v[40:43], v[8:11], v[120:127], v138
    s_cmp_lt_u32 s72, 4
    s_cbranch_scc1 L_comb99
    ds_write_b64 v134, v[36:37] offset:320
    s_waitcnt lgkmcnt(2)
    s_barrier
    s_nop 2
    ds_write_b64 v134, v[40:41] offset:480
    s_waitcnt vmcnt(0) lgkmcnt(0)
L_comb99d:
    s_barrier
    s_branch L_ocomb100
L_comb99:
    ds_write_b64 v134, v[36:37] offset:320
    s_nop 4
    ds_write_b64 v134, v[40:41] offset:480
    s_cmp_lg_u32 s72, 0
    s_waitcnt lgkmcnt(0)
    v_add_u32 v33, 2432, v44
    s_barrier
    s_cbranch_scc1 L_comb99d
    ds_read_b64 v[20:21], v45 offset:61760
    ds_read2_b64 v[4:7], v44 offset0:0 offset1:76
    ds_read2_b64 v[8:11], v44 offset0:152 offset1:228
    s_barrier
    ds_read2_b64 v[12:15], v33 offset0:0 offset1:76
    ds_read2_b64 v[16:19], v33 offset0:152 offset1:228
    s_waitcnt lgkmcnt(4)
    v_max_f32_dpp v22, v20, v20 quad_perm:[1,0,3,2] row_mask:0xf bank_mask:0xf
    s_nop 1
    v_max_f32_dpp v22, v22, v22 quad_perm:[2,3,0,1] row_mask:0xf bank_mask:0xf
    s_nop 1
    v_max_f32_dpp v22, v22, v22 row_half_mirror row_mask:0xf bank_mask:0xf
    v_sub_f32 v23, v20, v22
    v_exp_f32 v23, v23
    s_nop 0
    v_mul_f32 v24, v23, v21
    s_waitcnt lgkmcnt(2)
    v_mul_f32_dpp v26, v23, v4 row_newbcast:0 row_mask:0xf bank_mask:0xf
    v_mul_f32_dpp v27, v23, v5 row_newbcast:0 row_mask:0xf bank_mask:0xf
    v_add_f32_dpp v24, v24, v24 quad_perm:[1,0,3,2] row_mask:0xf bank_mask:0xf
    v_fmac_f32_dpp v26, v23, v6 row_newbcast:1 row_mask:0xf bank_mask:0xf
    v_fmac_f32_dpp v27, v23, v7 row_newbcast:1 row_mask:0xf bank_mask:0xf
    v_add_f32_dpp v24, v24, v24 quad_perm:[2,3,0,1] row_mask:0xf bank_mask:0xf
    v_fmac_f32_dpp v26, v23, v8 row_newbcast:2 row_mask:0xf bank_mask:0xf
    v_fmac_f32_dpp v27, v23, v9 row_newbcast:2 row_mask:0xf bank_mask:0xf
    v_add_f32_dpp v24, v24, v24 row_half_mirror row_mask:0xf bank_mask:0xf
    v_fmac_f32_dpp v26, v23, v10 row_newbcast:3 row_mask:0xf bank_mask:0xf
    v_fmac_f32_dpp v27, v23, v11 row_newbcast:3 row_mask:0xf bank_mask:0xf
    v_rcp_f32 v25, v24
    s_waitcnt lgkmcnt(1)
    v_fmac_f32_dpp v26, v23, v12 row_newbcast:4 row_mask:0xf bank_mask:0xf
    v_fmac_f32_dpp v27, v23, v13 row_newbcast:4 row_mask:0xf bank_mask:0xf
    v_log_f32 v24, v24
    v_fmac_f32_dpp v26, v23, v14 row_newbcast:5 row_mask:0xf bank_mask:0xf
    v_fmac_f32_dpp v27, v23, v15 row_newbcast:5 row_mask:0xf bank_mask:0xf
    v_add_f32 v22, v22, v24
    s_waitcnt lgkmcnt(0)
    v_fmac_f32_dpp v26, v23, v16 row_newbcast:6 row_mask:0xf bank_mask:0xf
    v_fmac_f32_dpp v27, v23, v17 row_newbcast:6 row_mask:0xf bank_mask:0xf
    s_cmp_eq_u32 s89, 0
    s_cbranch_scc1 L_sc1_101
    v_fmac_f32_dpp v26, v23, v18 row_newbcast:7 row_mask:0xf bank_mask:0xf
    v_fmac_f32_dpp v27, v23, v19 row_newbcast:7 row_mask:0xf bank_mask:0xf
    v_mul_f32 v26, v26, v25
    v_mul_f32 v27, v27, v25
    v_cvt_pk_bf16_f32 v26, v26, v27
    buffer_store_dword v26, v46, s[56:59], 0 offen
    buffer_store_dword v22, v141, s[56:59], s93 offen offset:2048
L_sc1_101r:
L_ocomb100:
    s_waitcnt vmcnt(0)
    s_barrier
    s_cmp_lt_u32 s72, 4
    s_cbranch_scc0 L_wos102
    s_mov_b32 s83, 540672
L_poll103:
    buffer_load_dword v12, v51, s[56:59], 0 offen offset:2048 sc1
    buffer_load_dwordx4 v[4:7], v50, s[56:59], 0 offen sc1
    buffer_load_dwordx4 v[8:11], v50, s[56:59], 0 offen offset:1024 sc1
    s_add_u32 s81, s81, 1
    s_cmp_gt_u32 s81, 4000000
    s_cbranch_scc1 L_end
    s_waitcnt vmcnt(1) lgkmcnt(0)
    v_mfma_f32_16x16x32_bf16 v[20:23], a[76:79], v[4:7], 0
    v_sub_f32_dpp v13, v12, v12 quad_perm:[1,0,3,2] row_mask:0xf bank_mask:0xf
    v_mfma_f32_16x16x32_bf16 v[16:19], a[72:75], v[4:7], 0
    v_exp_f32 v13, v13
    s_waitcnt vmcnt(0)
    v_mfma_f32_16x16x32_bf16 v[20:23], a[84:87], v[8:11], v[20:23]
    v_add_f32 v13, 1.0, v13
    v_mfma_f32_16x16x32_bf16 v[16:19], a[80:83], v[8:11], v[16:19]
    v_rcp_f32 v13, v13
    v_max3_u32 v47, v4, v5, v6
    v_max3_u32 v47, v47, v7, v8
    v_max3_u32 v47, v47, v9, v10
    v_max3_u32 v47, v47, v11, v12
    v_cmp_eq_u32 vcc, -1, v47
    s_cbranch_vccnz L_poll103
    s_nop 0
    v_add_f32_dpp v16, v20, v16 row_ror:8 row_mask:0xf bank_mask:0xf
    v_add_f32_dpp v17, v21, v17 row_ror:8 row_mask:0xf bank_mask:0xf
    v_add_f32_dpp v18, v22, v18 row_ror:8 row_mask:0xf bank_mask:0xf
    v_add_f32_dpp v19, v23, v19 row_ror:8 row_mask:0xf bank_mask:0xf
    v_mul_f32 v16, v16, v13
    v_mul_f32 v17, v17, v13
    v_mul_f32 v18, v18, v13
    v_mul_f32 v19, v19, v13
    v_add_f32_dpp v16, v16, v16 quad_perm:[1,0,3,2] row_mask:0xf bank_mask:0xf
    v_add_f32_dpp v17, v17, v17 quad_perm:[1,0,3,2] row_mask:0xf bank_mask:0xf
    v_add_f32_dpp v18, v18, v18 quad_perm:[1,0,3,2] row_mask:0xf bank_mask:0xf
    v_add_f32_dpp v19, v19, v19 quad_perm:[1,0,3,2] row_mask:0xf bank_mask:0xf
    v_cvt_pk_bf16_f32 v16, v16, v17
    v_cvt_pk_bf16_f32 v17, v18, v19
    buffer_store_dwordx2 v[16:17], v59, s[56:59], s83 offen sc1
L_wos102:
    s_barrier
    s_cmp_lt_u32 s72, 4
    s_cbranch_scc1 L_xi104
    s_add_u32 s82, s94, 540672
    s_sleep 9
L_xp106:
    buffer_load_dwordx4 v[4:7], v52, s[56:59], s82 offen offset:0 sc1
    buffer_load_dwordx4 v[8:11], v52, s[56:59], s82 offen offset:1024 sc1
    buffer_load_dwordx4 v[12:15], v52, s[56:59], s82 offen offset:2048 sc1
    buffer_load_dwordx4 v[16:19], v52, s[56:59], s82 offen offset:3072 sc1
    s_add_u32 s81, s81, 1
    s_cmp_gt_u32 s81, 4000000
    s_cbranch_scc1 L_end
    s_waitcnt vmcnt(3)
    v_mfma_f32_16x16x32_bf16 v[44:47], a[108:111], v[4:7], v[62:65]
    v_max3_u32 v4, v4, v5, v6
    v_max_u32 v4, v4, v7
    s_waitcnt vmcnt(2)
    v_mfma_f32_16x16x32_bf16 v[44:47], a[108:111], v[8:11], v[44:47]
    v_max3_u32 v4, v4, v8, v9
    v_max3_u32 v4, v4, v10, v11
    s_waitcnt vmcnt(1)
    v_mfma_f32_16x16x32_bf16 v[44:47], a[108:111], v[12:15], v[44:47]
    v_max3_u32 v4, v4, v12, v13
    v_max3_u32 v4, v4, v14, v15
    s_waitcnt vmcnt(0)
    v_mfma_f32_16x16x32_bf16 v[44:47], a[108:111], v[16:19], v[44:47]
    v_max3_u32 v4, v4, v16, v17
    v_max3_u32 v4, v4, v18, v19
    v_cmp_eq_u32 vcc, -1, v4
    s_cbranch_vccnz L_xp106
    s_nop 3
    v_add_f32_dpp v44, v44, v44 row_ror:8 row_mask:0xf bank_mask:0xf
    v_add_f32_dpp v45, v45, v45 row_ror:8 row_mask:0xf bank_mask:0xf
    v_cvt_pk_bf16_f32 v4, v44, v45
    ds_write_b32 v61, v4
    v_lshlrev_b32 v6, 16, v4
    v_and_b32 v7, 0xffff0000, v4
    s_nop 0
    v_mov_b32_dpp v62, v6 quad_perm:[0,1,2,3] row_mask:0xf bank_mask:0x3
    v_mov_b32_dpp v63, v7 quad_perm:[0,1,2,3] row_mask:0xf bank_mask:0x3
    s_branch L_xs105
L_xi104:
    v_accvgpr_read_b32 v28, a104
    v_accvgpr_read_b32 v32, a104
    v_accvgpr_read_b32 v29, a105
    v_accvgpr_read_b32 v33, a105
    v_accvgpr_read_b32 v30, a106
    v_accvgpr_read_b32 v34, a106
    v_accvgpr_read_b32 v31, a107
    v_accvgpr_read_b32 v35, a107
    v_mov_b32 v37, 0
    v_mov_b32 v38, 0x3727c5ac
    v_mov_b32 v39, 0xc0135761
    s_lshl_b32 s82, s72, 7
    s_mov_b32 s83, 802816
    v_mov_b32_dpp v28, v37 quad_perm:[0,1,2,3] row_mask:0xf bank_mask:0xc
    v_mov_b32_dpp v29, v37 quad_perm:[0,1,2,3] row_mask:0xf bank_mask:0xc
    v_mov_b32_dpp v30, v37 quad_perm:[0,1,2,3] row_mask:0xf bank_mask:0xc
    v_mov_b32_dpp v31, v37 quad_perm:[0,1,2,3] row_mask:0xf bank_mask:0xc
    v_mov_b32_dpp v32, v37 quad_perm:[0,1,2,3] row_mask:0xf bank_mask:0x3
    v_mov_b32_dpp v33, v37 quad_perm:[0,1,2,3] row_mask:0xf bank_mask:0x3
    v_mov_b32_dpp v34, v37 quad_perm:[0,1,2,3] row_mask:0xf bank_mask:0x3
    v_mov_b32_dpp v35, v37 quad_perm:[0,1,2,3] row_mask:0xf bank_mask:0x3
L_xs105:
    s_waitcnt lgkmcnt(0)
    s_barrier
    ds_read_b128 v[4:7], v128
    ds_read_b128 v[8:11], v128 offset:64
    s_cmp_ge_u32 s72, 6
    s_cbranch_scc1 L_gu6107
    s_waitcnt lgkmcnt(1)
    v_mfma_f32_16x16x32_bf16 v[12:15], a[88:91], v[4:7], 0
    s_waitcnt lgkmcnt(0)
    v_mfma_f32_16x16x32_bf16 v[12:15], a[92:95], v[8:11], v[12:15]
    s_cmp_eq_u32 s89, 0
    s_cbranch_scc1 L_sc1_109
    s_nop 5
    v_cvt_pk_bf16_f32 v12, v12, v13
    v_cvt_pk_bf16_f32 v13, v14, v15
    buffer_store_dwordx2 v[12:13], v57, s[56:59], 0 offen
L_sc1_109r:
    s_cmp_ge_u32 s72, 3
    s_cbranch_scc1 L_gud108
    s_waitcnt vmcnt(0)
L_poll110:
    buffer_load_dwordx2 v[16:17], v55, s[56:59], 0 offen offset:2688 sc1
    buffer_load_dwordx4 v[8:11], v48, s[56:59], s82 offen offset:2560 sc1
    buffer_load_dwordx4 v[12:15], v48, s[56:59], s82 offen offset:2688 sc1
    s_add_u32 s81, s81, 1
    s_cmp_gt_u32 s81, 4000000
    s_cbranch_scc1 L_end
    s_waitcnt vmcnt(2)
    v_add_f32_dpp v36, v16, v16 quad_perm:[1,0,3,2] row_mask:0xf bank_mask:0xf
    v_add_f32_dpp v37, v17, v17 quad_perm:[1,0,3,2] row_mask:0xf bank_mask:0xf
    s_waitcnt vmcnt(1)
    v_mfma_f32_16x16x32_bf16 v[4:7], v[8:11], v[28:31], 0
    v_add_f32_dpp v36, v36, v36 quad_perm:[2,3,0,1] row_mask:0xf bank_mask:0xf
    v_add_f32_dpp v37, v37, v37 quad_perm:[2,3,0,1] row_mask:0xf bank_mask:0xf
    s_waitcnt vmcnt(0)
    v_mfma_f32_16x16x32_bf16 v[4:7], v[12:15], v[32:35], v[4:7]
    v_max3_u32 v47, v8, v9, v10
    v_max3_u32 v47, v47, v11, v12
    v_max3_u32 v47, v47, v13, v14
    v_max3_u32 v47, v47, v15, v16
    v_max_u32 v47, v47, v17
    v_cmp_eq_u32 vcc, -1, v47
    s_cbranch_vccnz L_poll110
    v_add_f32_dpp v36, v36, v36 row_half_mirror row_mask:0xf bank_mask:0xf
    v_add_f32_dpp v37, v37, v37 row_half_mirror row_mask:0xf bank_mask:0xf
    v_permlane32_swap_b32 v4, v5
    v_permlane32_swap_b32 v6, v7
    v_add_f32 v4, v4, v5
    v_add_f32 v8, v6, v7
    v_fmamk_f32 v36, v36, 0x3b000000, v38
    v_fma_f32 v36, -v37, v37, v36
    v_permlane16_swap_b32 v4, v8
    v_max_f32 v36, v36, v38
    v_rsq_f32 v36, v36
    v_fma_f32 v4, -v37, v53, v4
    v_mul_f32 v4, v4, v36
    v_mul_f32 v5, v4, v4
    v_fmac_f32 v39, 0xbdd2d3e8, v5
    v_mul_f32 v6, v39, v4
    v_exp_f32 v6, v6
    v_fma_f32 v8, -v37, v58, v8
    v_add_f32 v6, 1.0, v6
    v_rcp_f32 v6, v6
    v_mul_f32 v8, v8, v36
    v_mul_f32 v4, v4, v6
    v_mul_f32 v8, v8, v4
    v_cvt_pk_bf16_f32 v8, v8, v8
    ds_write_b16 v135, v8
    s_branch L_gud108
L_gu6107:
    s_cmp_lg_u32 s72, 7
    s_cbranch_scc1 L_gud108
    s_waitcnt lgkmcnt(1)
    v_mfma_f32_16x16x32_bf16 v[16:19], v[4:7], v[4:7], 0
    s_waitcnt lgkmcnt(0)
    v_mfma_f32_16x16x32_bf16 v[16:19], v[8:11], v[8:11], v[16:19]
    s_cmp_eq_u32 s89, 0
    s_cbranch_scc1 L_sc1_111
    s_nop 5
    v_cndmask_b32 v16, v16, v17, s[12:13]
    v_cndmask_b32 v18, v18, v19, s[16:17]
    v_cndmask_b32 v16, v16, v18, s[14:15]
    buffer_store_dword v16, v53, s[56:59], 0 offen offset:2688
L_sc1_111r:
L_gud108:
    s_waitcnt lgkmcnt(0)
    s_barrier
    s_cmp_lt_u32 s72, 4
    s_cbranch_scc0 L_dn112
    ds_read_b128 v[4:7], v136
    ds_read_b128 v[8:11], v136 offset:64
    s_waitcnt lgkmcnt(1)
    v_mfma_f32_16x16x32_bf16 v[12:15], a[96:99], v[4:7], 0
    s_waitcnt lgkmcnt(0)
    v_mfma_f32_16x16x32_bf16 v[12:15], a[100:103], v[8:11], v[12:15]
    s_nop 7
    v_cvt_pk_bf16_f32 v12, v12, v13
    v_cvt_pk_bf16_f32 v13, v14, v15
    buffer_store_dwordx2 v[12:13], v60, s[56:59], s83 offen sc1
L_dn112:
    s_cmp_lg_u32 s87, 0
    s_cbranch_scc1 L_fin0
    s_barrier
    s_sub_u32 s77, s72, 4
    s_cmp_lg_u32 s77, s70
    s_cbranch_scc1 L_fin
    s_add_u32 s82, s94, 802816
    s_sleep 9
L_xp113:
    buffer_load_dwordx4 v[4:7], v52, s[56:59], s82 offen offset:0 sc1
    buffer_load_dwordx4 v[8:11], v52, s[56:59], s82 offen offset:1024 sc1
    buffer_load_dwordx4 v[12:15], v52, s[56:59], s82 offen offset:2048 sc1
    buffer_load_dwordx4 v[16:19], v52, s[56:59], s82 offen offset:3072 sc1
    s_add_u32 s81, s81, 1
    s_cmp_gt_u32 s81, 4000000
    s_cbranch_scc1 L_end
    s_waitcnt vmcnt(3)
    v_mfma_f32_16x16x32_bf16 v[44:47], a[108:111], v[4:7], v[62:65]
    v_max3_u32 v4, v4, v5, v6
    v_max_u32 v4, v4, v7
    s_waitcnt vmcnt(2)
    v_mfma_f32_16x16x32_bf16 v[44:47], a[108:111], v[8:11], v[44:47]
    v_max3_u32 v4, v4, v8, v9
    v_max3_u32 v4, v4, v10, v11
    s_waitcnt vmcnt(1)
    v_mfma_f32_16x16x32_bf16 v[44:47], a[108:111], v[12:15], v[44:47]
    v_max3_u32 v4, v4, v12, v13
    v_max3_u32 v4, v4, v14, v15
    s_waitcnt vmcnt(0)
    v_mfma_f32_16x16x32_bf16 v[44:47], a[108:111], v[16:19], v[44:47]
    v_max3_u32 v4, v4, v16, v17
    v_max3_u32 v4, v4, v18, v19
    v_cmp_eq_u32 vcc, -1, v4
    s_cbranch_vccnz L_xp113
    s_nop 3
    v_add_f32_dpp v44, v44, v44 row_ror:8 row_mask:0xf bank_mask:0xf
    v_add_f32_dpp v45, v45, v45 row_ror:8 row_mask:0xf bank_mask:0xf
    v_cvt_pk_bf16_f32 v4, v44, v45
    buffer_store_dword v4, v0, s[64:67], 0 offen
    s_endpgm
L_fin0:
    s_lshl_b32 s77, s2, 3
    s_add_u32 s77, s77, s72
    s_cmp_lg_u32 s77, 15
    s_cbranch_scc1 L_fin
    v_mov_b32 v4, s88
    buffer_store_dword v4, v141, s[56:59], 0 offen offset:0 sc1
L_fin:
L_end:
    s_endpgm
L_sc1_32:
    s_nop 7
    buffer_store_dwordx4 v[28:31], v35, s[56:59], s76 offen sc1
    s_nop 1
    s_branch L_sc1_32r
L_sc1_37:
    s_nop 7
    buffer_store_dwordx4 v[12:15], v43, s[56:59], 0 offen sc1
    buffer_store_dwordx4 v[16:19], v33, s[56:59], 0 offen sc1
    s_nop 1
    s_branch L_sc1_37r
L_sc1_61:
    s_nop 7
    buffer_store_dwordx4 v[20:23], v140, s[56:59], s75 offen offset:2560 sc1
    s_nop 1
    s_branch L_sc1_61r
L_sc1_71:
    s_nop 7
    v_fmac_f32_dpp v26, v23, v18 row_newbcast:7 row_mask:0xf bank_mask:0xf
    v_fmac_f32_dpp v27, v23, v19 row_newbcast:7 row_mask:0xf bank_mask:0xf
    v_mul_f32 v26, v26, v25
    v_mul_f32 v27, v27, v25
    v_cvt_pk_bf16_f32 v26, v26, v27
    buffer_store_dword v26, v46, s[56:59], 0 offen sc1
    buffer_store_dword v22, v141, s[56:59], s93 offen offset:2048 sc1
    s_nop 1
    s_branch L_sc1_71r
L_sc1_76:
    s_nop 7
    buffer_store_dwordx4 v[12:15], v140, s[56:59], s75 offen offset:0 sc1
    buffer_store_dwordx4 v[12:15], v140, s[56:59], s75 offen offset:1024 sc1
    s_nop 1
    s_branch L_sc1_76r
L_sc1_82:
    s_nop 7
    v_cvt_pk_bf16_f32 v12, v12, v13
    v_cvt_pk_bf16_f32 v13, v14, v15
    buffer_store_dwordx2 v[12:13], v57, s[56:59], 0 offen sc1
    s_nop 1
    s_branch L_sc1_82r
L_sc1_84:
    s_nop 7
    v_cndmask_b32 v16, v16, v17, s[12:13]
    v_cndmask_b32 v18, v18, v19, s[16:17]
    v_cndmask_b32 v16, v16, v18, s[14:15]
    buffer_store_dword v16, v53, s[56:59], 0 offen offset:2176 sc1
    s_nop 1
    s_branch L_sc1_84r
L_sc1_90:
    s_nop 7
    buffer_store_dwordx4 v[12:15], v16, s[56:59], s77 offen sc1
    buffer_store_dword v12, v141, s[56:59], s93 offen offset:2048 sc1
    s_nop 1
    s_branch L_sc1_90r
L_sc1_94:
    s_nop 7
    buffer_store_dwordx4 v[12:15], v56, s[56:59], 0 offen sc1
    s_nop 1
    s_branch L_sc1_94r
L_sc1_95:
    s_nop 7
    v_cndmask_b32 v16, v16, v17, s[12:13]
    v_cndmask_b32 v18, v18, v19, s[16:17]
    v_cndmask_b32 v16, v16, v18, s[14:15]
    buffer_store_dwordx4 v[12:15], v56, s[56:59], 0 offen sc1
    buffer_store_dword v16, v53, s[56:59], 0 offen offset:2432 sc1
    s_nop 1
    s_branch L_sc1_95r
L_sc1_98:
    s_nop 7
    buffer_store_dwordx4 v[44:47], v140, s[56:59], s75 offen offset:2560 sc1
    s_nop 1
    s_branch L_sc1_98r
L_sc1_101:
    s_nop 7
    v_fmac_f32_dpp v26, v23, v18 row_newbcast:7 row_mask:0xf bank_mask:0xf
    v_fmac_f32_dpp v27, v23, v19 row_newbcast:7 row_mask:0xf bank_mask:0xf
    v_mul_f32 v26, v26, v25
    v_mul_f32 v27, v27, v25
    v_cvt_pk_bf16_f32 v26, v26, v27
    buffer_store_dword v26, v46, s[56:59], 0 offen sc1
    buffer_store_dword v22, v141, s[56:59], s93 offen offset:2048 sc1
    s_nop 1
    s_branch L_sc1_101r
L_sc1_109:
    s_nop 7
    v_cvt_pk_bf16_f32 v12, v12, v13
    v_cvt_pk_bf16_f32 v13, v14, v15
    buffer_store_dwordx2 v[12:13], v57, s[56:59], 0 offen sc1
    s_nop 1
    s_branch L_sc1_109r
L_sc1_111:
    s_nop 7
    v_cndmask_b32 v16, v16, v17, s[12:13]
    v_cndmask_b32 v18, v18, v19, s[16:17]
    v_cndmask_b32 v16, v16, v18, s[14:15]
    buffer_store_dword v16, v53, s[56:59], 0 offen offset:2688 sc1
    s_nop 1
    s_branch L_sc1_111r

.section .rodata,"a"
.p2align 6
.amdhsa_kernel interleave_layers__sliding_block_cached__geglu_ffn__decode_kernel
  .amdhsa_next_free_vgpr 256
  .amdhsa_next_free_sgpr 102
  .amdhsa_accum_offset 144
  .amdhsa_group_segment_fixed_size 0
  .amdhsa_kernarg_size 96
  .amdhsa_user_sgpr_count 2
  .amdhsa_user_sgpr_kernarg_segment_ptr 1
  .amdhsa_system_sgpr_workgroup_id_x 1
  .amdhsa_float_denorm_mode_32 3
  .amdhsa_float_denorm_mode_16_64 3
.end_amdhsa_kernel
```
